```python
import torch

def _softmax(x, axis=-1):
    return torch.softmax(x, dim=axis)
def _gelu(x):
    return torch.nn.functional.gelu(x, approximate="tanh")
def _silu(x):
    return torch.nn.functional.silu(x)
def _sigmoid(x):
    return torch.sigmoid(x)
def _layernorm(x, axis=-1, eps=1e-5):
    m = x.mean(dim=axis, keepdim=True)
    v = x.var(dim=axis, keepdim=True, unbiased=False)
    return (x - m) / torch.sqrt(v + eps)
def _scatter_add(tgt, idx, src, axis=0):
    return tgt.clone().index_add_(axis, idx, src)
def _segment_sum(src, seg, n):
    out = torch.zeros((n,) + src.shape[1:], dtype=src.dtype)
    return out.index_add_(0, seg, src)
def _pad(x, pw):
    flat = tuple(v for pair in reversed(pw) for v in pair)
    return torch.nn.functional.pad(x, flat)

kernel_name = 'standalone__self_sup_conv_stem_hubert__speech'

def setup_inputs():

    _w = (lambda a: (lambda t: t.to(torch.bfloat16) if t.is_floating_point() else t)(torch.as_tensor(a)))
    B, T, D, K = 2, 16000, 512, 5
    scale = (1.0 / (K * D)) ** 0.5
    return {
        "x": _w((lambda *s: torch.randn(*s, dtype=torch.bfloat16) * 0.05)(B, T, D)),
        "w": _w((lambda *s: torch.randn(*s, dtype=torch.bfloat16) * 0.05)(K, D, D) * scale),
        "b": _w((lambda *s: torch.randn(*s, dtype=torch.bfloat16) * 0.05)(D) * 0.1),
        "gamma": _w(torch.ones((D,), dtype=float)),
        "beta": _w(torch.zeros((D,), dtype=float)),
    }

def reference(x, w, b, gamma, beta):
    B, T, D = x.shape
    K = w.shape[0]
    s = 2
    L = (T - K) // s + 1
    y = torch.einsum('blc,cd->bld', x[:, 0 : s * L : s, :], w[0])
    for i in range(1, K):
        y = y + torch.einsum('blc,cd->bld', x[:, i : i + s * L : s, :], w[i])
    y = y + b[None, None, :]
    mu = y.mean(1, keepdims=True)
    var = ((y - mu) ** 2).mean(1, keepdims=True)
    yn = (y - mu) / torch.sqrt(var + 1e-5)
    yn = yn * gamma[None, None, :] + beta[None, None, :]
    return _gelu(yn)
```

```asm
; @launch grid=(256,1,1) block=(512,1,1) lds=149504
.amdgcn_target "amdgcn-amd-amdhsa--gfx950"
.text
.globl standalone__self_sup_conv_stem_hubert__speech_kernel
.p2align 8
.type standalone__self_sup_conv_stem_hubert__speech_kernel,@function
standalone__self_sup_conv_stem_hubert__speech_kernel:
    s_cmp_ge_u32 s2, 256
    s_cbranch_scc1 L_k1_end
    s_load_dwordx4 s[28:31], s[0:1], 0
    s_load_dwordx2 s[32:33], s[0:1], 16
    s_load_dwordx2 s[34:35], s[0:1], 56
    s_load_dwordx4 s[48:51], s[0:1], 24
    s_load_dwordx4 s[52:55], s[0:1], 40
    s_and_b32 s3, s2, 7
    s_lshr_b32 s27, s2, 3
    s_and_b32 s19, s27, 3
    s_lshr_b32 s27, s27, 2
    s_lshl_b32 s20, s3, 3
    s_add_u32 s20, s20, s27
    s_lshr_b32 s21, s20, 5
    s_and_b32 s22, s20, 31
    v_lshrrev_b32 v1, 6, v0
    s_nop 1
    v_readfirstlane_b32 s16, v1
    s_nop 3
    s_lshr_b32 s17, s16, 1
    s_and_b32 s17, s17, 1
    s_and_b32 s18, s16, 1
    s_and_b32 s59, s16, 3
    s_lshl_b32 s25, s59, 10
    s_mul_i32 s36, s21, 16384000
    s_lshl_b32 s37, s22, 19
    s_add_u32 s36, s36, s37
    s_lshl_b32 s37, s59, 14
    s_add_u32 s38, s36, s37
    s_lshl_b32 s39, s59, 12
    s_lshl_b32 s37, s19, 8
    s_add_u32 s39, s39, s37
    s_mov_b32 s42, 0
    s_mov_b32 s43, 0
    v_and_b32 v1, 63, v0
    s_lshl_b32 s3, s18, 2
    v_lshrrev_b32 v2, 4, v1
    v_add_u32 v2, s3, v2
    v_and_b32 v3, 7, v1
    v_xor_b32 v3, v3, v2
    v_lshlrev_b32 v3, 4, v3
    v_lshrrev_b32 v4, 3, v1
    v_lshlrev_b32 v4, 11, v4
    v_add_u32 v8, v3, v4
    v_lshrrev_b32 v2, 4, v1
    v_and_b32 v3, 15, v1
    v_lshrrev_b32 v4, 2, v3
    v_xor_b32 v4, v4, v2
    v_lshlrev_b32 v4, 6, v4
    v_lshlrev_b32 v5, 10, v2
    v_add_u32 v4, v4, v5
    v_and_b32 v5, 3, v1
    v_lshlrev_b32 v5, 4, v5
    v_add_u32 v9, v4, v5
    s_waitcnt lgkmcnt(0)
    s_mov_b32 s4, s28
    s_and_b32 s5, s29, 0xffff
    s_mov_b32 s6, 32768000
    s_mov_b32 s7, 0x00020000
    s_mov_b32 s8, s30
    s_and_b32 s9, s31, 0xffff
    s_mov_b32 s10, 2621440
    s_mov_b32 s11, 0x00020000
    s_cmp_lt_u32 s16, 4
    s_cbranch_scc1 L_pro_compute
    s_add_u32 s23, s38, s42
    s_add_u32 s24, s39, s43
    s_add_u32 m0, s25, 67584
    s_add_u32 s26, s24, 0
    buffer_load_dwordx4 v9, s[8:11], s26 offen lds
    s_add_u32 m0, s25, 71680
    s_add_u32 s26, s24, 16384
    buffer_load_dwordx4 v9, s[8:11], s26 offen lds
    s_add_u32 m0, s25, 75776
    s_add_u32 s26, s24, 32768
    buffer_load_dwordx4 v9, s[8:11], s26 offen lds
    s_add_u32 m0, s25, 79872
    s_add_u32 s26, s24, 49152
    buffer_load_dwordx4 v9, s[8:11], s26 offen lds
    s_add_u32 m0, s25, 83968
    s_add_u32 s26, s24, 1048576
    buffer_load_dwordx4 v9, s[8:11], s26 offen lds
    s_add_u32 m0, s25, 88064
    s_add_u32 s26, s24, 1064960
    buffer_load_dwordx4 v9, s[8:11], s26 offen lds
    s_add_u32 m0, s25, 92160
    s_add_u32 s26, s24, 1081344
    buffer_load_dwordx4 v9, s[8:11], s26 offen lds
    s_add_u32 m0, s25, 96256
    s_add_u32 s26, s24, 1097728
    buffer_load_dwordx4 v9, s[8:11], s26 offen lds
    s_add_u32 m0, s25, 100352
    s_add_u32 s26, s24, 2097152
    buffer_load_dwordx4 v9, s[8:11], s26 offen lds
    s_add_u32 m0, s25, 104448
    s_add_u32 s26, s24, 2113536
    buffer_load_dwordx4 v9, s[8:11], s26 offen lds
    s_add_u32 m0, s25, 108544
    s_add_u32 s26, s24, 2129920
    buffer_load_dwordx4 v9, s[8:11], s26 offen lds
    s_add_u32 m0, s25, 112640
    s_add_u32 s26, s24, 2146304
    buffer_load_dwordx4 v9, s[8:11], s26 offen lds
    s_add_u32 m0, s25, 0
    s_add_u32 s26, s23, 0
    buffer_load_dwordx4 v8, s[4:7], s26 offen lds
    s_add_u32 m0, s25, 4096
    s_add_u32 s26, s23, 65536
    buffer_load_dwordx4 v8, s[4:7], s26 offen lds
    s_add_u32 m0, s25, 8192
    s_add_u32 s26, s23, 131072
    buffer_load_dwordx4 v8, s[4:7], s26 offen lds
    s_add_u32 m0, s25, 12288
    s_add_u32 s26, s23, 196608
    buffer_load_dwordx4 v8, s[4:7], s26 offen lds
    s_add_u32 m0, s25, 16384
    s_add_u32 s26, s23, 262144
    buffer_load_dwordx4 v8, s[4:7], s26 offen lds
    s_add_u32 m0, s25, 20480
    s_add_u32 s26, s23, 327680
    buffer_load_dwordx4 v8, s[4:7], s26 offen lds
    s_add_u32 m0, s25, 24576
    s_add_u32 s26, s23, 393216
    buffer_load_dwordx4 v8, s[4:7], s26 offen lds
    s_add_u32 m0, s25, 28672
    s_add_u32 s26, s23, 458752
    buffer_load_dwordx4 v8, s[4:7], s26 offen lds
    s_cmp_lg_u32 s59, 0
    s_cbranch_scc1 L_noextra_p0
    s_mov_b32 m0, 32768
    s_add_u32 s26, s23, 524288
    buffer_load_dwordx4 v8, s[4:7], s26 offen lds
L_noextra_p0:
    s_add_u32 m0, s25, 116736
    s_add_u32 s26, s24, 524288
    buffer_load_dwordx4 v9, s[8:11], s26 offen lds
    s_add_u32 m0, s25, 120832
    s_add_u32 s26, s24, 540672
    buffer_load_dwordx4 v9, s[8:11], s26 offen lds
    s_add_u32 m0, s25, 124928
    s_add_u32 s26, s24, 557056
    buffer_load_dwordx4 v9, s[8:11], s26 offen lds
    s_add_u32 m0, s25, 129024
    s_add_u32 s26, s24, 573440
    buffer_load_dwordx4 v9, s[8:11], s26 offen lds
    s_mov_b32 s12, s34
    s_and_b32 s13, s35, 0xffff
    s_mov_b32 s14, 262144
    s_mov_b32 s15, 0x00020000
    s_mov_b32 s64, s52
    s_and_b32 s65, s53, 0xffff
    s_mov_b32 s66, 16379904
    s_mov_b32 s67, 0x00020000
    s_waitcnt vmcnt(4)
    s_barrier
L_ld_loop:
    s_add_u32 s24, s39, s43
    s_add_u32 m0, s25, 133120
    s_add_u32 s26, s24, 1572864
    buffer_load_dwordx4 v9, s[8:11], s26 offen lds
    s_add_u32 m0, s25, 137216
    s_add_u32 s26, s24, 1589248
    buffer_load_dwordx4 v9, s[8:11], s26 offen lds
    s_add_u32 m0, s25, 141312
    s_add_u32 s26, s24, 1605632
    buffer_load_dwordx4 v9, s[8:11], s26 offen lds
    s_add_u32 m0, s25, 145408
    s_add_u32 s26, s24, 1622016
    buffer_load_dwordx4 v9, s[8:11], s26 offen lds
    s_add_u32 s23, s38, s42
    s_add_u32 s23, s23, 1024
    s_add_u32 m0, s25, 33792
    s_add_u32 s26, s23, 0
    buffer_load_dwordx4 v8, s[4:7], s26 offen lds
    s_add_u32 m0, s25, 37888
    s_add_u32 s26, s23, 65536
    buffer_load_dwordx4 v8, s[4:7], s26 offen lds
    s_add_u32 m0, s25, 41984
    s_add_u32 s26, s23, 131072
    buffer_load_dwordx4 v8, s[4:7], s26 offen lds
    s_add_u32 m0, s25, 46080
    s_add_u32 s26, s23, 196608
    buffer_load_dwordx4 v8, s[4:7], s26 offen lds
    s_add_u32 m0, s25, 50176
    s_add_u32 s26, s23, 262144
    buffer_load_dwordx4 v8, s[4:7], s26 offen lds
    s_add_u32 m0, s25, 54272
    s_add_u32 s26, s23, 327680
    buffer_load_dwordx4 v8, s[4:7], s26 offen lds
    s_add_u32 m0, s25, 58368
    s_add_u32 s26, s23, 393216
    buffer_load_dwordx4 v8, s[4:7], s26 offen lds
    s_add_u32 m0, s25, 62464
    s_add_u32 s26, s23, 458752
    buffer_load_dwordx4 v8, s[4:7], s26 offen lds
    s_cmp_lg_u32 s59, 0
    s_cbranch_scc1 L_noextra_t1
    s_mov_b32 m0, 66560
    s_add_u32 s26, s23, 524288
    buffer_load_dwordx4 v8, s[4:7], s26 offen lds
L_noextra_t1:
    s_cmp_lg_u32 s42, 896
    s_cbranch_scc1 L_w_t1
    s_waitcnt vmcnt(0)
L_w_t1:
    s_waitcnt vmcnt(28)
    s_barrier
    s_cmp_eq_u32 s42, 896
    s_cbranch_scc1 L_nodma_t2
    s_add_u32 s24, s39, s43
    s_add_u32 s24, s24, 65536
    s_add_u32 m0, s25, 67584
    s_add_u32 s26, s24, 0
    buffer_load_dwordx4 v9, s[8:11], s26 offen lds
    s_add_u32 m0, s25, 71680
    s_add_u32 s26, s24, 16384
    buffer_load_dwordx4 v9, s[8:11], s26 offen lds
    s_add_u32 m0, s25, 75776
    s_add_u32 s26, s24, 32768
    buffer_load_dwordx4 v9, s[8:11], s26 offen lds
    s_add_u32 m0, s25, 79872
    s_add_u32 s26, s24, 49152
    buffer_load_dwordx4 v9, s[8:11], s26 offen lds
L_nodma_t2:
    s_cmp_lg_u32 s42, 896
    s_cbranch_scc1 L_w_t2
    s_waitcnt vmcnt(0)
L_w_t2:
    s_waitcnt vmcnt(28)
    s_barrier
    s_cmp_eq_u32 s42, 896
    s_cbranch_scc1 L_nodma_t3
    s_add_u32 s24, s39, s43
    s_add_u32 s24, s24, 65536
    s_add_u32 m0, s25, 83968
    s_add_u32 s26, s24, 1048576
    buffer_load_dwordx4 v9, s[8:11], s26 offen lds
    s_add_u32 m0, s25, 88064
    s_add_u32 s26, s24, 1064960
    buffer_load_dwordx4 v9, s[8:11], s26 offen lds
    s_add_u32 m0, s25, 92160
    s_add_u32 s26, s24, 1081344
    buffer_load_dwordx4 v9, s[8:11], s26 offen lds
    s_add_u32 m0, s25, 96256
    s_add_u32 s26, s24, 1097728
    buffer_load_dwordx4 v9, s[8:11], s26 offen lds
L_nodma_t3:
    s_cmp_lg_u32 s42, 896
    s_cbranch_scc1 L_w_t3
    s_waitcnt vmcnt(0)
L_w_t3:
    s_waitcnt vmcnt(8)
    s_barrier
    s_cmp_eq_u32 s42, 896
    s_cbranch_scc1 L_nodma_t4
    s_add_u32 s24, s39, s43
    s_add_u32 s24, s24, 65536
    s_add_u32 m0, s25, 100352
    s_add_u32 s26, s24, 2097152
    buffer_load_dwordx4 v9, s[8:11], s26 offen lds
    s_add_u32 m0, s25, 104448
    s_add_u32 s26, s24, 2113536
    buffer_load_dwordx4 v9, s[8:11], s26 offen lds
    s_add_u32 m0, s25, 108544
    s_add_u32 s26, s24, 2129920
    buffer_load_dwordx4 v9, s[8:11], s26 offen lds
    s_add_u32 m0, s25, 112640
    s_add_u32 s26, s24, 2146304
    buffer_load_dwordx4 v9, s[8:11], s26 offen lds
    s_add_u32 s23, s38, s42
    s_add_u32 s23, s23, 128
    s_add_u32 m0, s25, 0
    s_add_u32 s26, s23, 0
    buffer_load_dwordx4 v8, s[4:7], s26 offen lds
    s_add_u32 m0, s25, 4096
    s_add_u32 s26, s23, 65536
    buffer_load_dwordx4 v8, s[4:7], s26 offen lds
    s_add_u32 m0, s25, 8192
    s_add_u32 s26, s23, 131072
    buffer_load_dwordx4 v8, s[4:7], s26 offen lds
    s_add_u32 m0, s25, 12288
    s_add_u32 s26, s23, 196608
    buffer_load_dwordx4 v8, s[4:7], s26 offen lds
    s_add_u32 m0, s25, 16384
    s_add_u32 s26, s23, 262144
    buffer_load_dwordx4 v8, s[4:7], s26 offen lds
    s_add_u32 m0, s25, 20480
    s_add_u32 s26, s23, 327680
    buffer_load_dwordx4 v8, s[4:7], s26 offen lds
    s_add_u32 m0, s25, 24576
    s_add_u32 s26, s23, 393216
    buffer_load_dwordx4 v8, s[4:7], s26 offen lds
    s_add_u32 m0, s25, 28672
    s_add_u32 s26, s23, 458752
    buffer_load_dwordx4 v8, s[4:7], s26 offen lds
    s_cmp_lg_u32 s59, 0
    s_cbranch_scc1 L_noextra_t4
    s_mov_b32 m0, 32768
    s_add_u32 s26, s23, 524288
    buffer_load_dwordx4 v8, s[4:7], s26 offen lds
L_noextra_t4:
L_nodma_t4:
    s_cmp_lg_u32 s42, 896
    s_cbranch_scc1 L_w_t4
    s_waitcnt vmcnt(0)
L_w_t4:
    s_waitcnt vmcnt(28)
    s_barrier
    s_cmp_eq_u32 s42, 896
    s_cbranch_scc1 L_nodma_t5
    s_add_u32 s24, s39, s43
    s_add_u32 s24, s24, 65536
    s_add_u32 m0, s25, 116736
    s_add_u32 s26, s24, 524288
    buffer_load_dwordx4 v9, s[8:11], s26 offen lds
    s_add_u32 m0, s25, 120832
    s_add_u32 s26, s24, 540672
    buffer_load_dwordx4 v9, s[8:11], s26 offen lds
    s_add_u32 m0, s25, 124928
    s_add_u32 s26, s24, 557056
    buffer_load_dwordx4 v9, s[8:11], s26 offen lds
    s_add_u32 m0, s25, 129024
    s_add_u32 s26, s24, 573440
    buffer_load_dwordx4 v9, s[8:11], s26 offen lds
L_nodma_t5:
    s_cmp_lg_u32 s42, 896
    s_cbranch_scc1 L_w_t5
    s_waitcnt vmcnt(0)
L_w_t5:
    s_waitcnt vmcnt(4)
    s_barrier
    s_add_u32 s42, s42, 128
    s_add_u32 s43, s43, 65536
    s_cmp_lt_u32 s42, 1024
    s_cbranch_scc1 L_ld_loop
    s_branch L_k1_epi
L_pro_compute:
    s_mov_b32 s12, s34
    s_and_b32 s13, s35, 0xffff
    s_mov_b32 s14, 262144
    s_mov_b32 s15, 0x00020000
    s_mov_b32 s64, s52
    s_and_b32 s65, s53, 0xffff
    s_mov_b32 s66, 16379904
    s_mov_b32 s67, 0x00020000
    s_lshl_b32 s3, s19, 7
    s_lshl_b32 s27, s18, 6
    s_add_u32 s3, s3, s27
    v_and_b32 v2, 31, v1
    v_add_u32 v2, s3, v2
    v_lshlrev_b32 v2, 1, v2
    global_load_ushort v10, v2, s[32:33]
    global_load_ushort v11, v2, s[32:33] offset:64
    global_load_ushort v12, v2, s[48:49]
    global_load_ushort v13, v2, s[48:49] offset:64
    global_load_ushort v14, v2, s[50:51]
    global_load_ushort v15, v2, s[50:51] offset:64
    v_and_b32 v2, 31, v1
    v_lshrrev_b32 v3, 5, v1
    s_lshl_b32 s3, s17, 14
    v_add_u32 v4, 0, v2
    v_lshrrev_b32 v5, 1, v4
    v_and_b32 v5, 7, v5
    v_lshlrev_b32 v4, 7, v4
    v_add_u32 v4, s3, v4
    v_add_u32 v6, 0, v3
    v_xor_b32 v6, v6, v5
    v_lshlrev_b32 v6, 4, v6
    v_add_u32 v64, v4, v6
    v_add_u32 v6, 2, v3
    v_xor_b32 v6, v6, v5
    v_lshlrev_b32 v6, 4, v6
    v_add_u32 v65, v4, v6
    v_add_u32 v6, 4, v3
    v_xor_b32 v6, v6, v5
    v_lshlrev_b32 v6, 4, v6
    v_add_u32 v66, v4, v6
    v_add_u32 v6, 6, v3
    v_xor_b32 v6, v6, v5
    v_lshlrev_b32 v6, 4, v6
    v_add_u32 v67, v4, v6
    v_add_u32 v4, 1, v2
    v_lshrrev_b32 v5, 1, v4
    v_and_b32 v5, 7, v5
    v_lshlrev_b32 v4, 7, v4
    v_add_u32 v4, s3, v4
    v_add_u32 v6, 0, v3
    v_xor_b32 v6, v6, v5
    v_lshlrev_b32 v6, 4, v6
    v_add_u32 v68, v4, v6
    v_add_u32 v6, 2, v3
    v_xor_b32 v6, v6, v5
    v_lshlrev_b32 v6, 4, v6
    v_add_u32 v69, v4, v6
    v_add_u32 v6, 4, v3
    v_xor_b32 v6, v6, v5
    v_lshlrev_b32 v6, 4, v6
    v_add_u32 v70, v4, v6
    v_add_u32 v6, 6, v3
    v_xor_b32 v6, v6, v5
    v_lshlrev_b32 v6, 4, v6
    v_add_u32 v71, v4, v6
    v_add_u32 v4, 2, v2
    v_lshrrev_b32 v5, 1, v4
    v_and_b32 v5, 7, v5
    v_lshlrev_b32 v4, 7, v4
    v_add_u32 v4, s3, v4
    v_add_u32 v6, 0, v3
    v_xor_b32 v6, v6, v5
    v_lshlrev_b32 v6, 4, v6
    v_add_u32 v72, v4, v6
    v_add_u32 v6, 2, v3
    v_xor_b32 v6, v6, v5
    v_lshlrev_b32 v6, 4, v6
    v_add_u32 v73, v4, v6
    v_add_u32 v6, 4, v3
    v_xor_b32 v6, v6, v5
    v_lshlrev_b32 v6, 4, v6
    v_add_u32 v74, v4, v6
    v_add_u32 v6, 6, v3
    v_xor_b32 v6, v6, v5
    v_lshlrev_b32 v6, 4, v6
    v_add_u32 v75, v4, v6
    v_and_b32 v2, 15, v1
    v_lshrrev_b32 v4, 2, v2
    v_lshlrev_b32 v5, 3, v3
    v_add_u32 v5, v5, v4
    v_lshlrev_b32 v5, 8, v5
    v_lshrrev_b32 v6, 4, v1
    v_and_b32 v6, 1, v6
    v_lshlrev_b32 v6, 5, v6
    v_add_u32 v5, v5, v6
    v_and_b32 v6, 3, v2
    v_lshlrev_b32 v6, 3, v6
    v_add_u32 v5, v5, v6
    s_lshl_b32 s3, s18, 1
    s_add_u32 s27, s3, 0
    v_xor_b32 v6, s27, v4
    v_lshlrev_b32 v6, 6, v6
    v_add_u32 v6, v6, v5
    v_add_u32 v76, 67584, v6
    v_add_u32 v78, 116736, v6
    s_add_u32 s27, s3, 1
    v_xor_b32 v6, s27, v4
    v_lshlrev_b32 v6, 6, v6
    v_add_u32 v6, v6, v5
    v_add_u32 v77, 67584, v6
    v_add_u32 v79, 116736, v6
    v_mov_b32 v40, 0
    v_mov_b32 v41, 0
    v_mov_b32 v42, 0
    v_mov_b32 v43, 0
    v_mov_b32 v44, 0
    v_mov_b32 v45, 0
    v_mov_b32 v46, 0
    v_mov_b32 v47, 0
    v_mov_b32 v48, 0
    v_mov_b32 v49, 0
    v_mov_b32 v50, 0
    v_mov_b32 v51, 0
    v_mov_b32 v52, 0
    v_mov_b32 v53, 0
    v_mov_b32 v54, 0
    v_mov_b32 v55, 0
    v_mov_b32 v56, 0
    v_mov_b32 v57, 0
    v_mov_b32 v58, 0
    v_mov_b32 v59, 0
    v_mov_b32 v60, 0
    v_mov_b32 v61, 0
    v_mov_b32 v62, 0
    v_mov_b32 v63, 0
    s_waitcnt vmcnt(4)
    v_lshlrev_b32 v10, 16, v10
    v_lshlrev_b32 v11, 16, v11
    v_mov_b32 v80, v10
    v_mov_b32 v81, v10
    v_mov_b32 v82, v10
    v_mov_b32 v83, v10
    v_mov_b32 v84, v10
    v_mov_b32 v85, v10
    v_mov_b32 v86, v10
    v_mov_b32 v87, v10
    v_mov_b32 v88, v10
    v_mov_b32 v89, v10
    v_mov_b32 v90, v10
    v_mov_b32 v91, v10
    v_mov_b32 v92, v10
    v_mov_b32 v93, v10
    v_mov_b32 v94, v10
    v_mov_b32 v95, v10
    v_mov_b32 v96, v11
    v_mov_b32 v97, v11
    v_mov_b32 v98, v11
    v_mov_b32 v99, v11
    v_mov_b32 v100, v11
    v_mov_b32 v101, v11
    v_mov_b32 v102, v11
    v_mov_b32 v103, v11
    v_mov_b32 v104, v11
    v_mov_b32 v105, v11
    v_mov_b32 v106, v11
    v_mov_b32 v107, v11
    v_mov_b32 v108, v11
    v_mov_b32 v109, v11
    v_mov_b32 v110, v11
    v_mov_b32 v111, v11
    v_mov_b32 v112, v10
    v_mov_b32 v113, v10
    v_mov_b32 v114, v10
    v_mov_b32 v115, v10
    v_mov_b32 v116, v10
    v_mov_b32 v117, v10
    v_mov_b32 v118, v10
    v_mov_b32 v119, v10
    v_mov_b32 v120, v10
    v_mov_b32 v121, v10
    v_mov_b32 v122, v10
    v_mov_b32 v123, v10
    v_mov_b32 v124, v10
    v_mov_b32 v125, v10
    v_mov_b32 v126, v10
    v_mov_b32 v127, v10
    v_mov_b32 v128, v11
    v_mov_b32 v129, v11
    v_mov_b32 v130, v11
    v_mov_b32 v131, v11
    v_mov_b32 v132, v11
    v_mov_b32 v133, v11
    v_mov_b32 v134, v11
    v_mov_b32 v135, v11
    v_mov_b32 v136, v11
    v_mov_b32 v137, v11
    v_mov_b32 v138, v11
    v_mov_b32 v139, v11
    v_mov_b32 v140, v11
    v_mov_b32 v141, v11
    v_mov_b32 v142, v11
    v_mov_b32 v143, v11
    v_mov_b32 v144, v10
    v_mov_b32 v145, v10
    v_mov_b32 v146, v10
    v_mov_b32 v147, v10
    v_mov_b32 v148, v10
    v_mov_b32 v149, v10
    v_mov_b32 v150, v10
    v_mov_b32 v151, v10
    v_mov_b32 v152, v10
    v_mov_b32 v153, v10
    v_mov_b32 v154, v10
    v_mov_b32 v155, v10
    v_mov_b32 v156, v10
    v_mov_b32 v157, v10
    v_mov_b32 v158, v10
    v_mov_b32 v159, v10
    v_mov_b32 v160, v11
    v_mov_b32 v161, v11
    v_mov_b32 v162, v11
    v_mov_b32 v163, v11
    v_mov_b32 v164, v11
    v_mov_b32 v165, v11
    v_mov_b32 v166, v11
    v_mov_b32 v167, v11
    v_mov_b32 v168, v11
    v_mov_b32 v169, v11
    v_mov_b32 v170, v11
    v_mov_b32 v171, v11
    v_mov_b32 v172, v11
    v_mov_b32 v173, v11
    v_mov_b32 v174, v11
    v_mov_b32 v175, v11
    v_mov_b32 v176, v10
    v_mov_b32 v177, v10
    v_mov_b32 v178, v10
    v_mov_b32 v179, v10
    v_mov_b32 v180, v10
    v_mov_b32 v181, v10
    v_mov_b32 v182, v10
    v_mov_b32 v183, v10
    v_mov_b32 v184, v10
    v_mov_b32 v185, v10
    v_mov_b32 v186, v10
    v_mov_b32 v187, v10
    v_mov_b32 v188, v10
    v_mov_b32 v189, v10
    v_mov_b32 v190, v10
    v_mov_b32 v191, v10
    v_mov_b32 v192, v11
    v_mov_b32 v193, v11
    v_mov_b32 v194, v11
    v_mov_b32 v195, v11
    v_mov_b32 v196, v11
    v_mov_b32 v197, v11
    v_mov_b32 v198, v11
    v_mov_b32 v199, v11
    v_mov_b32 v200, v11
    v_mov_b32 v201, v11
    v_mov_b32 v202, v11
    v_mov_b32 v203, v11
    v_mov_b32 v204, v11
    v_mov_b32 v205, v11
    v_mov_b32 v206, v11
    v_mov_b32 v207, v11
    s_barrier
L_k1_loop:
    v_mfma_f32_32x32x16_bf16 v[80:95], v[40:43], v[56:59], v[80:95]
    ds_read_b128 v[16:19], v64 offset:0
    v_mfma_f32_32x32x16_bf16 v[112:127], v[44:47], v[56:59], v[112:127]
    ds_read_b64_tr_b16 v[32:33], v76 offset:0
    v_mfma_f32_32x32x16_bf16 v[144:159], v[48:51], v[56:59], v[144:159]
    ds_read_b64_tr_b16 v[34:35], v76 offset:1024
    v_mfma_f32_32x32x16_bf16 v[176:191], v[52:55], v[56:59], v[176:191]
    ds_read_b128 v[20:23], v64 offset:4096
    v_mfma_f32_32x32x16_bf16 v[96:111], v[40:43], v[60:63], v[96:111]
    ds_read_b128 v[24:27], v64 offset:8192
    v_mfma_f32_32x32x16_bf16 v[128:143], v[44:47], v[60:63], v[128:143]
    ds_read_b128 v[28:31], v64 offset:12288
    v_mfma_f32_32x32x16_bf16 v[160:175], v[48:51], v[60:63], v[160:175]
    ds_read_b64_tr_b16 v[36:37], v77 offset:0
    v_mfma_f32_32x32x16_bf16 v[192:207], v[52:55], v[60:63], v[192:207]
    ds_read_b64_tr_b16 v[38:39], v77 offset:1024
    s_waitcnt lgkmcnt(5)
    v_mfma_f32_32x32x16_bf16 v[80:95], v[16:19], v[32:35], v[80:95]
    ds_read_b128 v[40:43], v65 offset:0
    s_waitcnt lgkmcnt(5)
    v_mfma_f32_32x32x16_bf16 v[112:127], v[20:23], v[32:35], v[112:127]
    ds_read_b64_tr_b16 v[56:57], v76 offset:4096
    s_waitcnt lgkmcnt(5)
    v_mfma_f32_32x32x16_bf16 v[144:159], v[24:27], v[32:35], v[144:159]
    ds_read_b64_tr_b16 v[58:59], v76 offset:5120
    s_waitcnt lgkmcnt(5)
    v_mfma_f32_32x32x16_bf16 v[176:191], v[28:31], v[32:35], v[176:191]
    ds_read_b128 v[44:47], v65 offset:4096
    s_waitcnt lgkmcnt(4)
    v_mfma_f32_32x32x16_bf16 v[96:111], v[16:19], v[36:39], v[96:111]
    ds_read_b128 v[48:51], v65 offset:8192
    v_mfma_f32_32x32x16_bf16 v[128:143], v[20:23], v[36:39], v[128:143]
    ds_read_b128 v[52:55], v65 offset:12288
    v_mfma_f32_32x32x16_bf16 v[160:175], v[24:27], v[36:39], v[160:175]
    ds_read_b64_tr_b16 v[60:61], v77 offset:4096
    v_mfma_f32_32x32x16_bf16 v[192:207], v[28:31], v[36:39], v[192:207]
    ds_read_b64_tr_b16 v[62:63], v77 offset:5120
    s_waitcnt lgkmcnt(5)
    v_mfma_f32_32x32x16_bf16 v[80:95], v[40:43], v[56:59], v[80:95]
    ds_read_b128 v[16:19], v66 offset:0
    s_waitcnt lgkmcnt(5)
    v_mfma_f32_32x32x16_bf16 v[112:127], v[44:47], v[56:59], v[112:127]
    ds_read_b64_tr_b16 v[32:33], v76 offset:8192
    s_waitcnt lgkmcnt(5)
    v_mfma_f32_32x32x16_bf16 v[144:159], v[48:51], v[56:59], v[144:159]
    ds_read_b64_tr_b16 v[34:35], v76 offset:9216
    s_waitcnt lgkmcnt(5)
    v_mfma_f32_32x32x16_bf16 v[176:191], v[52:55], v[56:59], v[176:191]
    ds_read_b128 v[20:23], v66 offset:4096
    s_waitcnt lgkmcnt(4)
    v_mfma_f32_32x32x16_bf16 v[96:111], v[40:43], v[60:63], v[96:111]
    ds_read_b128 v[24:27], v66 offset:8192
    v_mfma_f32_32x32x16_bf16 v[128:143], v[44:47], v[60:63], v[128:143]
    ds_read_b128 v[28:31], v66 offset:12288
    v_mfma_f32_32x32x16_bf16 v[160:175], v[48:51], v[60:63], v[160:175]
    ds_read_b64_tr_b16 v[36:37], v77 offset:8192
    v_mfma_f32_32x32x16_bf16 v[192:207], v[52:55], v[60:63], v[192:207]
    ds_read_b64_tr_b16 v[38:39], v77 offset:9216
    s_waitcnt lgkmcnt(5)
    v_mfma_f32_32x32x16_bf16 v[80:95], v[16:19], v[32:35], v[80:95]
    ds_read_b128 v[40:43], v67 offset:0
    s_waitcnt lgkmcnt(5)
    v_mfma_f32_32x32x16_bf16 v[112:127], v[20:23], v[32:35], v[112:127]
    ds_read_b64_tr_b16 v[56:57], v76 offset:12288
    s_waitcnt lgkmcnt(5)
    v_mfma_f32_32x32x16_bf16 v[144:159], v[24:27], v[32:35], v[144:159]
    ds_read_b64_tr_b16 v[58:59], v76 offset:13312
    s_waitcnt lgkmcnt(5)
    v_mfma_f32_32x32x16_bf16 v[176:191], v[28:31], v[32:35], v[176:191]
    ds_read_b128 v[44:47], v67 offset:4096
    s_waitcnt lgkmcnt(4)
    v_mfma_f32_32x32x16_bf16 v[96:111], v[16:19], v[36:39], v[96:111]
    ds_read_b128 v[48:51], v67 offset:8192
    v_mfma_f32_32x32x16_bf16 v[128:143], v[20:23], v[36:39], v[128:143]
    ds_read_b128 v[52:55], v67 offset:12288
    v_mfma_f32_32x32x16_bf16 v[160:175], v[24:27], v[36:39], v[160:175]
    ds_read_b64_tr_b16 v[60:61], v77 offset:12288
    v_mfma_f32_32x32x16_bf16 v[192:207], v[28:31], v[36:39], v[192:207]
    ds_read_b64_tr_b16 v[62:63], v77 offset:13312
    s_waitcnt lgkmcnt(0)
    s_barrier
    v_mfma_f32_32x32x16_bf16 v[80:95], v[40:43], v[56:59], v[80:95]
    ds_read_b128 v[16:19], v68 offset:0
    v_mfma_f32_32x32x16_bf16 v[112:127], v[44:47], v[56:59], v[112:127]
    ds_read_b64_tr_b16 v[32:33], v76 offset:16384
    v_mfma_f32_32x32x16_bf16 v[144:159], v[48:51], v[56:59], v[144:159]
    ds_read_b64_tr_b16 v[34:35], v76 offset:17408
    v_mfma_f32_32x32x16_bf16 v[176:191], v[52:55], v[56:59], v[176:191]
    ds_read_b128 v[20:23], v68 offset:4096
    v_mfma_f32_32x32x16_bf16 v[96:111], v[40:43], v[60:63], v[96:111]
    ds_read_b128 v[24:27], v68 offset:8192
    v_mfma_f32_32x32x16_bf16 v[128:143], v[44:47], v[60:63], v[128:143]
    ds_read_b128 v[28:31], v68 offset:12288
    v_mfma_f32_32x32x16_bf16 v[160:175], v[48:51], v[60:63], v[160:175]
    ds_read_b64_tr_b16 v[36:37], v77 offset:16384
    v_mfma_f32_32x32x16_bf16 v[192:207], v[52:55], v[60:63], v[192:207]
    ds_read_b64_tr_b16 v[38:39], v77 offset:17408
    s_waitcnt lgkmcnt(5)
    v_mfma_f32_32x32x16_bf16 v[80:95], v[16:19], v[32:35], v[80:95]
    ds_read_b128 v[40:43], v69 offset:0
    s_waitcnt lgkmcnt(5)
    v_mfma_f32_32x32x16_bf16 v[112:127], v[20:23], v[32:35], v[112:127]
    ds_read_b64_tr_b16 v[56:57], v76 offset:20480
    s_waitcnt lgkmcnt(5)
    v_mfma_f32_32x32x16_bf16 v[144:159], v[24:27], v[32:35], v[144:159]
    ds_read_b64_tr_b16 v[58:59], v76 offset:21504
    s_waitcnt lgkmcnt(5)
    v_mfma_f32_32x32x16_bf16 v[176:191], v[28:31], v[32:35], v[176:191]
    ds_read_b128 v[44:47], v69 offset:4096
    s_waitcnt lgkmcnt(4)
    v_mfma_f32_32x32x16_bf16 v[96:111], v[16:19], v[36:39], v[96:111]
    ds_read_b128 v[48:51], v69 offset:8192
    v_mfma_f32_32x32x16_bf16 v[128:143], v[20:23], v[36:39], v[128:143]
    ds_read_b128 v[52:55], v69 offset:12288
    v_mfma_f32_32x32x16_bf16 v[160:175], v[24:27], v[36:39], v[160:175]
    ds_read_b64_tr_b16 v[60:61], v77 offset:20480
    v_mfma_f32_32x32x16_bf16 v[192:207], v[28:31], v[36:39], v[192:207]
    ds_read_b64_tr_b16 v[62:63], v77 offset:21504
    s_waitcnt lgkmcnt(5)
    v_mfma_f32_32x32x16_bf16 v[80:95], v[40:43], v[56:59], v[80:95]
    ds_read_b128 v[16:19], v70 offset:0
    s_waitcnt lgkmcnt(5)
    v_mfma_f32_32x32x16_bf16 v[112:127], v[44:47], v[56:59], v[112:127]
    ds_read_b64_tr_b16 v[32:33], v76 offset:24576
    s_waitcnt lgkmcnt(5)
    v_mfma_f32_32x32x16_bf16 v[144:159], v[48:51], v[56:59], v[144:159]
    ds_read_b64_tr_b16 v[34:35], v76 offset:25600
    s_waitcnt lgkmcnt(5)
    v_mfma_f32_32x32x16_bf16 v[176:191], v[52:55], v[56:59], v[176:191]
    ds_read_b128 v[20:23], v70 offset:4096
    s_waitcnt lgkmcnt(4)
    v_mfma_f32_32x32x16_bf16 v[96:111], v[40:43], v[60:63], v[96:111]
    ds_read_b128 v[24:27], v70 offset:8192
    v_mfma_f32_32x32x16_bf16 v[128:143], v[44:47], v[60:63], v[128:143]
    ds_read_b128 v[28:31], v70 offset:12288
    v_mfma_f32_32x32x16_bf16 v[160:175], v[48:51], v[60:63], v[160:175]
    ds_read_b64_tr_b16 v[36:37], v77 offset:24576
    v_mfma_f32_32x32x16_bf16 v[192:207], v[52:55], v[60:63], v[192:207]
    ds_read_b64_tr_b16 v[38:39], v77 offset:25600
    s_waitcnt lgkmcnt(5)
    v_mfma_f32_32x32x16_bf16 v[80:95], v[16:19], v[32:35], v[80:95]
    ds_read_b128 v[40:43], v71 offset:0
    s_waitcnt lgkmcnt(5)
    v_mfma_f32_32x32x16_bf16 v[112:127], v[20:23], v[32:35], v[112:127]
    ds_read_b64_tr_b16 v[56:57], v76 offset:28672
    s_waitcnt lgkmcnt(5)
    v_mfma_f32_32x32x16_bf16 v[144:159], v[24:27], v[32:35], v[144:159]
    ds_read_b64_tr_b16 v[58:59], v76 offset:29696
    s_waitcnt lgkmcnt(5)
    v_mfma_f32_32x32x16_bf16 v[176:191], v[28:31], v[32:35], v[176:191]
    ds_read_b128 v[44:47], v71 offset:4096
    s_waitcnt lgkmcnt(4)
    v_mfma_f32_32x32x16_bf16 v[96:111], v[16:19], v[36:39], v[96:111]
    ds_read_b128 v[48:51], v71 offset:8192
    v_mfma_f32_32x32x16_bf16 v[128:143], v[20:23], v[36:39], v[128:143]
    ds_read_b128 v[52:55], v71 offset:12288
    v_mfma_f32_32x32x16_bf16 v[160:175], v[24:27], v[36:39], v[160:175]
    ds_read_b64_tr_b16 v[60:61], v77 offset:28672
    v_mfma_f32_32x32x16_bf16 v[192:207], v[28:31], v[36:39], v[192:207]
    ds_read_b64_tr_b16 v[62:63], v77 offset:29696
    s_waitcnt lgkmcnt(0)
    s_barrier
    v_mfma_f32_32x32x16_bf16 v[80:95], v[40:43], v[56:59], v[80:95]
    ds_read_b128 v[16:19], v72 offset:0
    v_mfma_f32_32x32x16_bf16 v[112:127], v[44:47], v[56:59], v[112:127]
    ds_read_b64_tr_b16 v[32:33], v76 offset:32768
    v_mfma_f32_32x32x16_bf16 v[144:159], v[48:51], v[56:59], v[144:159]
    ds_read_b64_tr_b16 v[34:35], v76 offset:33792
    v_mfma_f32_32x32x16_bf16 v[176:191], v[52:55], v[56:59], v[176:191]
    ds_read_b128 v[20:23], v72 offset:4096
    v_mfma_f32_32x32x16_bf16 v[96:111], v[40:43], v[60:63], v[96:111]
    ds_read_b128 v[24:27], v72 offset:8192
    v_mfma_f32_32x32x16_bf16 v[128:143], v[44:47], v[60:63], v[128:143]
    ds_read_b128 v[28:31], v72 offset:12288
    v_mfma_f32_32x32x16_bf16 v[160:175], v[48:51], v[60:63], v[160:175]
    ds_read_b64_tr_b16 v[36:37], v77 offset:32768
    v_mfma_f32_32x32x16_bf16 v[192:207], v[52:55], v[60:63], v[192:207]
    ds_read_b64_tr_b16 v[38:39], v77 offset:33792
    s_waitcnt lgkmcnt(5)
    v_mfma_f32_32x32x16_bf16 v[80:95], v[16:19], v[32:35], v[80:95]
    ds_read_b128 v[40:43], v73 offset:0
    s_waitcnt lgkmcnt(5)
    v_mfma_f32_32x32x16_bf16 v[112:127], v[20:23], v[32:35], v[112:127]
    ds_read_b64_tr_b16 v[56:57], v76 offset:36864
    s_waitcnt lgkmcnt(5)
    v_mfma_f32_32x32x16_bf16 v[144:159], v[24:27], v[32:35], v[144:159]
    ds_read_b64_tr_b16 v[58:59], v76 offset:37888
    s_waitcnt lgkmcnt(5)
    v_mfma_f32_32x32x16_bf16 v[176:191], v[28:31], v[32:35], v[176:191]
    ds_read_b128 v[44:47], v73 offset:4096
    s_waitcnt lgkmcnt(4)
    v_mfma_f32_32x32x16_bf16 v[96:111], v[16:19], v[36:39], v[96:111]
    ds_read_b128 v[48:51], v73 offset:8192
    v_mfma_f32_32x32x16_bf16 v[128:143], v[20:23], v[36:39], v[128:143]
    ds_read_b128 v[52:55], v73 offset:12288
    v_mfma_f32_32x32x16_bf16 v[160:175], v[24:27], v[36:39], v[160:175]
    ds_read_b64_tr_b16 v[60:61], v77 offset:36864
    v_mfma_f32_32x32x16_bf16 v[192:207], v[28:31], v[36:39], v[192:207]
    ds_read_b64_tr_b16 v[62:63], v77 offset:37888
    s_waitcnt lgkmcnt(5)
    v_mfma_f32_32x32x16_bf16 v[80:95], v[40:43], v[56:59], v[80:95]
    ds_read_b128 v[16:19], v74 offset:0
    s_waitcnt lgkmcnt(5)
    v_mfma_f32_32x32x16_bf16 v[112:127], v[44:47], v[56:59], v[112:127]
    ds_read_b64_tr_b16 v[32:33], v76 offset:40960
    s_waitcnt lgkmcnt(5)
    v_mfma_f32_32x32x16_bf16 v[144:159], v[48:51], v[56:59], v[144:159]
    ds_read_b64_tr_b16 v[34:35], v76 offset:41984
    s_waitcnt lgkmcnt(5)
    v_mfma_f32_32x32x16_bf16 v[176:191], v[52:55], v[56:59], v[176:191]
    ds_read_b128 v[20:23], v74 offset:4096
    s_waitcnt lgkmcnt(4)
    v_mfma_f32_32x32x16_bf16 v[96:111], v[40:43], v[60:63], v[96:111]
    ds_read_b128 v[24:27], v74 offset:8192
    v_mfma_f32_32x32x16_bf16 v[128:143], v[44:47], v[60:63], v[128:143]
    ds_read_b128 v[28:31], v74 offset:12288
    v_mfma_f32_32x32x16_bf16 v[160:175], v[48:51], v[60:63], v[160:175]
    ds_read_b64_tr_b16 v[36:37], v77 offset:40960
    v_mfma_f32_32x32x16_bf16 v[192:207], v[52:55], v[60:63], v[192:207]
    ds_read_b64_tr_b16 v[38:39], v77 offset:41984
    s_waitcnt lgkmcnt(5)
    v_mfma_f32_32x32x16_bf16 v[80:95], v[16:19], v[32:35], v[80:95]
    ds_read_b128 v[40:43], v75 offset:0
    s_waitcnt lgkmcnt(5)
    v_mfma_f32_32x32x16_bf16 v[112:127], v[20:23], v[32:35], v[112:127]
    ds_read_b64_tr_b16 v[56:57], v76 offset:45056
    s_waitcnt lgkmcnt(5)
    v_mfma_f32_32x32x16_bf16 v[144:159], v[24:27], v[32:35], v[144:159]
    ds_read_b64_tr_b16 v[58:59], v76 offset:46080
    s_waitcnt lgkmcnt(5)
    v_mfma_f32_32x32x16_bf16 v[176:191], v[28:31], v[32:35], v[176:191]
    ds_read_b128 v[44:47], v75 offset:4096
    s_waitcnt lgkmcnt(4)
    v_mfma_f32_32x32x16_bf16 v[96:111], v[16:19], v[36:39], v[96:111]
    ds_read_b128 v[48:51], v75 offset:8192
    v_mfma_f32_32x32x16_bf16 v[128:143], v[20:23], v[36:39], v[128:143]
    ds_read_b128 v[52:55], v75 offset:12288
    v_mfma_f32_32x32x16_bf16 v[160:175], v[24:27], v[36:39], v[160:175]
    ds_read_b64_tr_b16 v[60:61], v77 offset:45056
    v_mfma_f32_32x32x16_bf16 v[192:207], v[28:31], v[36:39], v[192:207]
    ds_read_b64_tr_b16 v[62:63], v77 offset:46080
    s_waitcnt lgkmcnt(0)
    s_barrier
    v_mfma_f32_32x32x16_bf16 v[80:95], v[40:43], v[56:59], v[80:95]
    ds_read_b128 v[16:19], v64 offset:33792
    v_mfma_f32_32x32x16_bf16 v[112:127], v[44:47], v[56:59], v[112:127]
    ds_read_b64_tr_b16 v[32:33], v78 offset:0
    v_mfma_f32_32x32x16_bf16 v[144:159], v[48:51], v[56:59], v[144:159]
    ds_read_b64_tr_b16 v[34:35], v78 offset:1024
    v_mfma_f32_32x32x16_bf16 v[176:191], v[52:55], v[56:59], v[176:191]
    ds_read_b128 v[20:23], v64 offset:37888
    v_mfma_f32_32x32x16_bf16 v[96:111], v[40:43], v[60:63], v[96:111]
    ds_read_b128 v[24:27], v64 offset:41984
    v_mfma_f32_32x32x16_bf16 v[128:143], v[44:47], v[60:63], v[128:143]
    ds_read_b128 v[28:31], v64 offset:46080
    v_mfma_f32_32x32x16_bf16 v[160:175], v[48:51], v[60:63], v[160:175]
    ds_read_b64_tr_b16 v[36:37], v79 offset:0
    v_mfma_f32_32x32x16_bf16 v[192:207], v[52:55], v[60:63], v[192:207]
    ds_read_b64_tr_b16 v[38:39], v79 offset:1024
    s_waitcnt lgkmcnt(5)
    v_mfma_f32_32x32x16_bf16 v[80:95], v[16:19], v[32:35], v[80:95]
    ds_read_b128 v[40:43], v65 offset:33792
    s_waitcnt lgkmcnt(5)
    v_mfma_f32_32x32x16_bf16 v[112:127], v[20:23], v[32:35], v[112:127]
    ds_read_b64_tr_b16 v[56:57], v78 offset:4096
    s_waitcnt lgkmcnt(5)
    v_mfma_f32_32x32x16_bf16 v[144:159], v[24:27], v[32:35], v[144:159]
    ds_read_b64_tr_b16 v[58:59], v78 offset:5120
    s_waitcnt lgkmcnt(5)
    v_mfma_f32_32x32x16_bf16 v[176:191], v[28:31], v[32:35], v[176:191]
    ds_read_b128 v[44:47], v65 offset:37888
    s_waitcnt lgkmcnt(4)
    v_mfma_f32_32x32x16_bf16 v[96:111], v[16:19], v[36:39], v[96:111]
    ds_read_b128 v[48:51], v65 offset:41984
    v_mfma_f32_32x32x16_bf16 v[128:143], v[20:23], v[36:39], v[128:143]
    ds_read_b128 v[52:55], v65 offset:46080
    v_mfma_f32_32x32x16_bf16 v[160:175], v[24:27], v[36:39], v[160:175]
    ds_read_b64_tr_b16 v[60:61], v79 offset:4096
    v_mfma_f32_32x32x16_bf16 v[192:207], v[28:31], v[36:39], v[192:207]
    ds_read_b64_tr_b16 v[62:63], v79 offset:5120
    s_waitcnt lgkmcnt(5)
    v_mfma_f32_32x32x16_bf16 v[80:95], v[40:43], v[56:59], v[80:95]
    ds_read_b128 v[16:19], v66 offset:33792
    s_waitcnt lgkmcnt(5)
    v_mfma_f32_32x32x16_bf16 v[112:127], v[44:47], v[56:59], v[112:127]
    ds_read_b64_tr_b16 v[32:33], v78 offset:8192
    s_waitcnt lgkmcnt(5)
    v_mfma_f32_32x32x16_bf16 v[144:159], v[48:51], v[56:59], v[144:159]
    ds_read_b64_tr_b16 v[34:35], v78 offset:9216
    s_waitcnt lgkmcnt(5)
    v_mfma_f32_32x32x16_bf16 v[176:191], v[52:55], v[56:59], v[176:191]
    ds_read_b128 v[20:23], v66 offset:37888
    s_waitcnt lgkmcnt(4)
    v_mfma_f32_32x32x16_bf16 v[96:111], v[40:43], v[60:63], v[96:111]
    ds_read_b128 v[24:27], v66 offset:41984
    v_mfma_f32_32x32x16_bf16 v[128:143], v[44:47], v[60:63], v[128:143]
    ds_read_b128 v[28:31], v66 offset:46080
    v_mfma_f32_32x32x16_bf16 v[160:175], v[48:51], v[60:63], v[160:175]
    ds_read_b64_tr_b16 v[36:37], v79 offset:8192
    v_mfma_f32_32x32x16_bf16 v[192:207], v[52:55], v[60:63], v[192:207]
    ds_read_b64_tr_b16 v[38:39], v79 offset:9216
    s_waitcnt lgkmcnt(5)
    v_mfma_f32_32x32x16_bf16 v[80:95], v[16:19], v[32:35], v[80:95]
    ds_read_b128 v[40:43], v67 offset:33792
    s_waitcnt lgkmcnt(5)
    v_mfma_f32_32x32x16_bf16 v[112:127], v[20:23], v[32:35], v[112:127]
    ds_read_b64_tr_b16 v[56:57], v78 offset:12288
    s_waitcnt lgkmcnt(5)
    v_mfma_f32_32x32x16_bf16 v[144:159], v[24:27], v[32:35], v[144:159]
    ds_read_b64_tr_b16 v[58:59], v78 offset:13312
    s_waitcnt lgkmcnt(5)
    v_mfma_f32_32x32x16_bf16 v[176:191], v[28:31], v[32:35], v[176:191]
    ds_read_b128 v[44:47], v67 offset:37888
    s_waitcnt lgkmcnt(4)
    v_mfma_f32_32x32x16_bf16 v[96:111], v[16:19], v[36:39], v[96:111]
    ds_read_b128 v[48:51], v67 offset:41984
    v_mfma_f32_32x32x16_bf16 v[128:143], v[20:23], v[36:39], v[128:143]
    ds_read_b128 v[52:55], v67 offset:46080
    v_mfma_f32_32x32x16_bf16 v[160:175], v[24:27], v[36:39], v[160:175]
    ds_read_b64_tr_b16 v[60:61], v79 offset:12288
    v_mfma_f32_32x32x16_bf16 v[192:207], v[28:31], v[36:39], v[192:207]
    ds_read_b64_tr_b16 v[62:63], v79 offset:13312
    s_waitcnt lgkmcnt(0)
    s_barrier
    v_mfma_f32_32x32x16_bf16 v[80:95], v[40:43], v[56:59], v[80:95]
    ds_read_b128 v[16:19], v68 offset:33792
    v_mfma_f32_32x32x16_bf16 v[112:127], v[44:47], v[56:59], v[112:127]
    ds_read_b64_tr_b16 v[32:33], v78 offset:16384
    v_mfma_f32_32x32x16_bf16 v[144:159], v[48:51], v[56:59], v[144:159]
    ds_read_b64_tr_b16 v[34:35], v78 offset:17408
    v_mfma_f32_32x32x16_bf16 v[176:191], v[52:55], v[56:59], v[176:191]
    ds_read_b128 v[20:23], v68 offset:37888
    v_mfma_f32_32x32x16_bf16 v[96:111], v[40:43], v[60:63], v[96:111]
    ds_read_b128 v[24:27], v68 offset:41984
    v_mfma_f32_32x32x16_bf16 v[128:143], v[44:47], v[60:63], v[128:143]
    ds_read_b128 v[28:31], v68 offset:46080
    v_mfma_f32_32x32x16_bf16 v[160:175], v[48:51], v[60:63], v[160:175]
    ds_read_b64_tr_b16 v[36:37], v79 offset:16384
    v_mfma_f32_32x32x16_bf16 v[192:207], v[52:55], v[60:63], v[192:207]
    ds_read_b64_tr_b16 v[38:39], v79 offset:17408
    s_waitcnt lgkmcnt(5)
    v_mfma_f32_32x32x16_bf16 v[80:95], v[16:19], v[32:35], v[80:95]
    ds_read_b128 v[40:43], v69 offset:33792
    s_waitcnt lgkmcnt(5)
    v_mfma_f32_32x32x16_bf16 v[112:127], v[20:23], v[32:35], v[112:127]
    ds_read_b64_tr_b16 v[56:57], v78 offset:20480
    s_waitcnt lgkmcnt(5)
    v_mfma_f32_32x32x16_bf16 v[144:159], v[24:27], v[32:35], v[144:159]
    ds_read_b64_tr_b16 v[58:59], v78 offset:21504
    s_waitcnt lgkmcnt(5)
    v_mfma_f32_32x32x16_bf16 v[176:191], v[28:31], v[32:35], v[176:191]
    ds_read_b128 v[44:47], v69 offset:37888
    s_waitcnt lgkmcnt(4)
    v_mfma_f32_32x32x16_bf16 v[96:111], v[16:19], v[36:39], v[96:111]
    ds_read_b128 v[48:51], v69 offset:41984
    v_mfma_f32_32x32x16_bf16 v[128:143], v[20:23], v[36:39], v[128:143]
    ds_read_b128 v[52:55], v69 offset:46080
    v_mfma_f32_32x32x16_bf16 v[160:175], v[24:27], v[36:39], v[160:175]
    ds_read_b64_tr_b16 v[60:61], v79 offset:20480
    v_mfma_f32_32x32x16_bf16 v[192:207], v[28:31], v[36:39], v[192:207]
    ds_read_b64_tr_b16 v[62:63], v79 offset:21504
    s_waitcnt lgkmcnt(5)
    v_mfma_f32_32x32x16_bf16 v[80:95], v[40:43], v[56:59], v[80:95]
    ds_read_b128 v[16:19], v70 offset:33792
    s_waitcnt lgkmcnt(5)
    v_mfma_f32_32x32x16_bf16 v[112:127], v[44:47], v[56:59], v[112:127]
    ds_read_b64_tr_b16 v[32:33], v78 offset:24576
    s_waitcnt lgkmcnt(5)
    v_mfma_f32_32x32x16_bf16 v[144:159], v[48:51], v[56:59], v[144:159]
    ds_read_b64_tr_b16 v[34:35], v78 offset:25600
    s_waitcnt lgkmcnt(5)
    v_mfma_f32_32x32x16_bf16 v[176:191], v[52:55], v[56:59], v[176:191]
    ds_read_b128 v[20:23], v70 offset:37888
    s_waitcnt lgkmcnt(4)
    v_mfma_f32_32x32x16_bf16 v[96:111], v[40:43], v[60:63], v[96:111]
    ds_read_b128 v[24:27], v70 offset:41984
    v_mfma_f32_32x32x16_bf16 v[128:143], v[44:47], v[60:63], v[128:143]
    ds_read_b128 v[28:31], v70 offset:46080
    v_mfma_f32_32x32x16_bf16 v[160:175], v[48:51], v[60:63], v[160:175]
    ds_read_b64_tr_b16 v[36:37], v79 offset:24576
    v_mfma_f32_32x32x16_bf16 v[192:207], v[52:55], v[60:63], v[192:207]
    ds_read_b64_tr_b16 v[38:39], v79 offset:25600
    s_waitcnt lgkmcnt(5)
    v_mfma_f32_32x32x16_bf16 v[80:95], v[16:19], v[32:35], v[80:95]
    ds_read_b128 v[40:43], v71 offset:33792
    s_waitcnt lgkmcnt(5)
    v_mfma_f32_32x32x16_bf16 v[112:127], v[20:23], v[32:35], v[112:127]
    ds_read_b64_tr_b16 v[56:57], v78 offset:28672
    s_waitcnt lgkmcnt(5)
    v_mfma_f32_32x32x16_bf16 v[144:159], v[24:27], v[32:35], v[144:159]
    ds_read_b64_tr_b16 v[58:59], v78 offset:29696
    s_waitcnt lgkmcnt(5)
    v_mfma_f32_32x32x16_bf16 v[176:191], v[28:31], v[32:35], v[176:191]
    ds_read_b128 v[44:47], v71 offset:37888
    s_waitcnt lgkmcnt(4)
    v_mfma_f32_32x32x16_bf16 v[96:111], v[16:19], v[36:39], v[96:111]
    ds_read_b128 v[48:51], v71 offset:41984
    v_mfma_f32_32x32x16_bf16 v[128:143], v[20:23], v[36:39], v[128:143]
    ds_read_b128 v[52:55], v71 offset:46080
    v_mfma_f32_32x32x16_bf16 v[160:175], v[24:27], v[36:39], v[160:175]
    ds_read_b64_tr_b16 v[60:61], v79 offset:28672
    v_mfma_f32_32x32x16_bf16 v[192:207], v[28:31], v[36:39], v[192:207]
    ds_read_b64_tr_b16 v[62:63], v79 offset:29696
    s_waitcnt lgkmcnt(0)
    s_barrier
    s_add_u32 s42, s42, 128
    s_add_u32 s43, s43, 65536
    s_cmp_lt_u32 s42, 1024
    s_cbranch_scc1 L_k1_loop
L_k1_afterloop:
    v_mfma_f32_32x32x16_bf16 v[80:95], v[40:43], v[56:59], v[80:95]
    v_mfma_f32_32x32x16_bf16 v[112:127], v[44:47], v[56:59], v[112:127]
    v_mfma_f32_32x32x16_bf16 v[144:159], v[48:51], v[56:59], v[144:159]
    v_mfma_f32_32x32x16_bf16 v[176:191], v[52:55], v[56:59], v[176:191]
    v_mfma_f32_32x32x16_bf16 v[96:111], v[40:43], v[60:63], v[96:111]
    v_mfma_f32_32x32x16_bf16 v[128:143], v[44:47], v[60:63], v[128:143]
    v_mfma_f32_32x32x16_bf16 v[160:175], v[48:51], v[60:63], v[160:175]
    v_mfma_f32_32x32x16_bf16 v[192:207], v[52:55], v[60:63], v[192:207]
L_k1_epi:
    s_nop 15
    s_nop 7
    v_and_b32 v1, 63, v0
    v_lshrrev_b32 v3, 5, v1
    s_cmp_ge_u32 s16, 4
    s_cbranch_scc1 L_k1_sums_done
    s_lshl_b32 s3, s17, 7
    v_lshlrev_b32 v4, 2, v3
    v_add_u32 v4, s3, v4
    s_lshl_b32 s27, s22, 8
    s_sub_u32 s46, 7998, s27
    s_cmp_lg_u32 s22, 31
    s_cbranch_scc1 L_k1_noedge
    v_add_u32 v5, 0, v4
    v_cmp_gt_u32 vcc, s46, v5
    s_nop 1
    v_cndmask_b32 v80, 0, v80, vcc
    v_cndmask_b32 v96, 0, v96, vcc
    v_add_u32 v5, 1, v4
    v_cmp_gt_u32 vcc, s46, v5
    s_nop 1
    v_cndmask_b32 v81, 0, v81, vcc
    v_cndmask_b32 v97, 0, v97, vcc
    v_add_u32 v5, 2, v4
    v_cmp_gt_u32 vcc, s46, v5
    s_nop 1
    v_cndmask_b32 v82, 0, v82, vcc
    v_cndmask_b32 v98, 0, v98, vcc
    v_add_u32 v5, 3, v4
    v_cmp_gt_u32 vcc, s46, v5
    s_nop 1
    v_cndmask_b32 v83, 0, v83, vcc
    v_cndmask_b32 v99, 0, v99, vcc
    v_add_u32 v5, 8, v4
    v_cmp_gt_u32 vcc, s46, v5
    s_nop 1
    v_cndmask_b32 v84, 0, v84, vcc
    v_cndmask_b32 v100, 0, v100, vcc
    v_add_u32 v5, 9, v4
    v_cmp_gt_u32 vcc, s46, v5
    s_nop 1
    v_cndmask_b32 v85, 0, v85, vcc
    v_cndmask_b32 v101, 0, v101, vcc
    v_add_u32 v5, 10, v4
    v_cmp_gt_u32 vcc, s46, v5
    s_nop 1
    v_cndmask_b32 v86, 0, v86, vcc
    v_cndmask_b32 v102, 0, v102, vcc
    v_add_u32 v5, 11, v4
    v_cmp_gt_u32 vcc, s46, v5
    s_nop 1
    v_cndmask_b32 v87, 0, v87, vcc
    v_cndmask_b32 v103, 0, v103, vcc
    v_add_u32 v5, 16, v4
    v_cmp_gt_u32 vcc, s46, v5
    s_nop 1
    v_cndmask_b32 v88, 0, v88, vcc
    v_cndmask_b32 v104, 0, v104, vcc
    v_add_u32 v5, 17, v4
    v_cmp_gt_u32 vcc, s46, v5
    s_nop 1
    v_cndmask_b32 v89, 0, v89, vcc
    v_cndmask_b32 v105, 0, v105, vcc
    v_add_u32 v5, 18, v4
    v_cmp_gt_u32 vcc, s46, v5
    s_nop 1
    v_cndmask_b32 v90, 0, v90, vcc
    v_cndmask_b32 v106, 0, v106, vcc
    v_add_u32 v5, 19, v4
    v_cmp_gt_u32 vcc, s46, v5
    s_nop 1
    v_cndmask_b32 v91, 0, v91, vcc
    v_cndmask_b32 v107, 0, v107, vcc
    v_add_u32 v5, 24, v4
    v_cmp_gt_u32 vcc, s46, v5
    s_nop 1
    v_cndmask_b32 v92, 0, v92, vcc
    v_cndmask_b32 v108, 0, v108, vcc
    v_add_u32 v5, 25, v4
    v_cmp_gt_u32 vcc, s46, v5
    s_nop 1
    v_cndmask_b32 v93, 0, v93, vcc
    v_cndmask_b32 v109, 0, v109, vcc
    v_add_u32 v5, 26, v4
    v_cmp_gt_u32 vcc, s46, v5
    s_nop 1
    v_cndmask_b32 v94, 0, v94, vcc
    v_cndmask_b32 v110, 0, v110, vcc
    v_add_u32 v5, 27, v4
    v_cmp_gt_u32 vcc, s46, v5
    s_nop 1
    v_cndmask_b32 v95, 0, v95, vcc
    v_cndmask_b32 v111, 0, v111, vcc
    v_add_u32 v5, 32, v4
    v_cmp_gt_u32 vcc, s46, v5
    s_nop 1
    v_cndmask_b32 v112, 0, v112, vcc
    v_cndmask_b32 v128, 0, v128, vcc
    v_add_u32 v5, 33, v4
    v_cmp_gt_u32 vcc, s46, v5
    s_nop 1
    v_cndmask_b32 v113, 0, v113, vcc
    v_cndmask_b32 v129, 0, v129, vcc
    v_add_u32 v5, 34, v4
    v_cmp_gt_u32 vcc, s46, v5
    s_nop 1
    v_cndmask_b32 v114, 0, v114, vcc
    v_cndmask_b32 v130, 0, v130, vcc
    v_add_u32 v5, 35, v4
    v_cmp_gt_u32 vcc, s46, v5
    s_nop 1
    v_cndmask_b32 v115, 0, v115, vcc
    v_cndmask_b32 v131, 0, v131, vcc
    v_add_u32 v5, 40, v4
    v_cmp_gt_u32 vcc, s46, v5
    s_nop 1
    v_cndmask_b32 v116, 0, v116, vcc
    v_cndmask_b32 v132, 0, v132, vcc
    v_add_u32 v5, 41, v4
    v_cmp_gt_u32 vcc, s46, v5
    s_nop 1
    v_cndmask_b32 v117, 0, v117, vcc
    v_cndmask_b32 v133, 0, v133, vcc
    v_add_u32 v5, 42, v4
    v_cmp_gt_u32 vcc, s46, v5
    s_nop 1
    v_cndmask_b32 v118, 0, v118, vcc
    v_cndmask_b32 v134, 0, v134, vcc
    v_add_u32 v5, 43, v4
    v_cmp_gt_u32 vcc, s46, v5
    s_nop 1
    v_cndmask_b32 v119, 0, v119, vcc
    v_cndmask_b32 v135, 0, v135, vcc
    v_add_u32 v5, 48, v4
    v_cmp_gt_u32 vcc, s46, v5
    s_nop 1
    v_cndmask_b32 v120, 0, v120, vcc
    v_cndmask_b32 v136, 0, v136, vcc
    v_add_u32 v5, 49, v4
    v_cmp_gt_u32 vcc, s46, v5
    s_nop 1
    v_cndmask_b32 v121, 0, v121, vcc
    v_cndmask_b32 v137, 0, v137, vcc
    v_add_u32 v5, 50, v4
    v_cmp_gt_u32 vcc, s46, v5
    s_nop 1
    v_cndmask_b32 v122, 0, v122, vcc
    v_cndmask_b32 v138, 0, v138, vcc
    v_add_u32 v5, 51, v4
    v_cmp_gt_u32 vcc, s46, v5
    s_nop 1
    v_cndmask_b32 v123, 0, v123, vcc
    v_cndmask_b32 v139, 0, v139, vcc
    v_add_u32 v5, 56, v4
    v_cmp_gt_u32 vcc, s46, v5
    s_nop 1
    v_cndmask_b32 v124, 0, v124, vcc
    v_cndmask_b32 v140, 0, v140, vcc
    v_add_u32 v5, 57, v4
    v_cmp_gt_u32 vcc, s46, v5
    s_nop 1
    v_cndmask_b32 v125, 0, v125, vcc
    v_cndmask_b32 v141, 0, v141, vcc
    v_add_u32 v5, 58, v4
    v_cmp_gt_u32 vcc, s46, v5
    s_nop 1
    v_cndmask_b32 v126, 0, v126, vcc
    v_cndmask_b32 v142, 0, v142, vcc
    v_add_u32 v5, 59, v4
    v_cmp_gt_u32 vcc, s46, v5
    s_nop 1
    v_cndmask_b32 v127, 0, v127, vcc
    v_cndmask_b32 v143, 0, v143, vcc
    v_add_u32 v5, 64, v4
    v_cmp_gt_u32 vcc, s46, v5
    s_nop 1
    v_cndmask_b32 v144, 0, v144, vcc
    v_cndmask_b32 v160, 0, v160, vcc
    v_add_u32 v5, 65, v4
    v_cmp_gt_u32 vcc, s46, v5
    s_nop 1
    v_cndmask_b32 v145, 0, v145, vcc
    v_cndmask_b32 v161, 0, v161, vcc
    v_add_u32 v5, 66, v4
    v_cmp_gt_u32 vcc, s46, v5
    s_nop 1
    v_cndmask_b32 v146, 0, v146, vcc
    v_cndmask_b32 v162, 0, v162, vcc
    v_add_u32 v5, 67, v4
    v_cmp_gt_u32 vcc, s46, v5
    s_nop 1
    v_cndmask_b32 v147, 0, v147, vcc
    v_cndmask_b32 v163, 0, v163, vcc
    v_add_u32 v5, 72, v4
    v_cmp_gt_u32 vcc, s46, v5
    s_nop 1
    v_cndmask_b32 v148, 0, v148, vcc
    v_cndmask_b32 v164, 0, v164, vcc
    v_add_u32 v5, 73, v4
    v_cmp_gt_u32 vcc, s46, v5
    s_nop 1
    v_cndmask_b32 v149, 0, v149, vcc
    v_cndmask_b32 v165, 0, v165, vcc
    v_add_u32 v5, 74, v4
    v_cmp_gt_u32 vcc, s46, v5
    s_nop 1
    v_cndmask_b32 v150, 0, v150, vcc
    v_cndmask_b32 v166, 0, v166, vcc
    v_add_u32 v5, 75, v4
    v_cmp_gt_u32 vcc, s46, v5
    s_nop 1
    v_cndmask_b32 v151, 0, v151, vcc
    v_cndmask_b32 v167, 0, v167, vcc
    v_add_u32 v5, 80, v4
    v_cmp_gt_u32 vcc, s46, v5
    s_nop 1
    v_cndmask_b32 v152, 0, v152, vcc
    v_cndmask_b32 v168, 0, v168, vcc
    v_add_u32 v5, 81, v4
    v_cmp_gt_u32 vcc, s46, v5
    s_nop 1
    v_cndmask_b32 v153, 0, v153, vcc
    v_cndmask_b32 v169, 0, v169, vcc
    v_add_u32 v5, 82, v4
    v_cmp_gt_u32 vcc, s46, v5
    s_nop 1
    v_cndmask_b32 v154, 0, v154, vcc
    v_cndmask_b32 v170, 0, v170, vcc
    v_add_u32 v5, 83, v4
    v_cmp_gt_u32 vcc, s46, v5
    s_nop 1
    v_cndmask_b32 v155, 0, v155, vcc
    v_cndmask_b32 v171, 0, v171, vcc
    v_add_u32 v5, 88, v4
    v_cmp_gt_u32 vcc, s46, v5
    s_nop 1
    v_cndmask_b32 v156, 0, v156, vcc
    v_cndmask_b32 v172, 0, v172, vcc
    v_add_u32 v5, 89, v4
    v_cmp_gt_u32 vcc, s46, v5
    s_nop 1
    v_cndmask_b32 v157, 0, v157, vcc
    v_cndmask_b32 v173, 0, v173, vcc
    v_add_u32 v5, 90, v4
    v_cmp_gt_u32 vcc, s46, v5
    s_nop 1
    v_cndmask_b32 v158, 0, v158, vcc
    v_cndmask_b32 v174, 0, v174, vcc
    v_add_u32 v5, 91, v4
    v_cmp_gt_u32 vcc, s46, v5
    s_nop 1
    v_cndmask_b32 v159, 0, v159, vcc
    v_cndmask_b32 v175, 0, v175, vcc
    v_add_u32 v5, 96, v4
    v_cmp_gt_u32 vcc, s46, v5
    s_nop 1
    v_cndmask_b32 v176, 0, v176, vcc
    v_cndmask_b32 v192, 0, v192, vcc
    v_add_u32 v5, 97, v4
    v_cmp_gt_u32 vcc, s46, v5
    s_nop 1
    v_cndmask_b32 v177, 0, v177, vcc
    v_cndmask_b32 v193, 0, v193, vcc
    v_add_u32 v5, 98, v4
    v_cmp_gt_u32 vcc, s46, v5
    s_nop 1
    v_cndmask_b32 v178, 0, v178, vcc
    v_cndmask_b32 v194, 0, v194, vcc
    v_add_u32 v5, 99, v4
    v_cmp_gt_u32 vcc, s46, v5
    s_nop 1
    v_cndmask_b32 v179, 0, v179, vcc
    v_cndmask_b32 v195, 0, v195, vcc
    v_add_u32 v5, 104, v4
    v_cmp_gt_u32 vcc, s46, v5
    s_nop 1
    v_cndmask_b32 v180, 0, v180, vcc
    v_cndmask_b32 v196, 0, v196, vcc
    v_add_u32 v5, 105, v4
    v_cmp_gt_u32 vcc, s46, v5
    s_nop 1
    v_cndmask_b32 v181, 0, v181, vcc
    v_cndmask_b32 v197, 0, v197, vcc
    v_add_u32 v5, 106, v4
    v_cmp_gt_u32 vcc, s46, v5
    s_nop 1
    v_cndmask_b32 v182, 0, v182, vcc
    v_cndmask_b32 v198, 0, v198, vcc
    v_add_u32 v5, 107, v4
    v_cmp_gt_u32 vcc, s46, v5
    s_nop 1
    v_cndmask_b32 v183, 0, v183, vcc
    v_cndmask_b32 v199, 0, v199, vcc
    v_add_u32 v5, 112, v4
    v_cmp_gt_u32 vcc, s46, v5
    s_nop 1
    v_cndmask_b32 v184, 0, v184, vcc
    v_cndmask_b32 v200, 0, v200, vcc
    v_add_u32 v5, 113, v4
    v_cmp_gt_u32 vcc, s46, v5
    s_nop 1
    v_cndmask_b32 v185, 0, v185, vcc
    v_cndmask_b32 v201, 0, v201, vcc
    v_add_u32 v5, 114, v4
    v_cmp_gt_u32 vcc, s46, v5
    s_nop 1
    v_cndmask_b32 v186, 0, v186, vcc
    v_cndmask_b32 v202, 0, v202, vcc
    v_add_u32 v5, 115, v4
    v_cmp_gt_u32 vcc, s46, v5
    s_nop 1
    v_cndmask_b32 v187, 0, v187, vcc
    v_cndmask_b32 v203, 0, v203, vcc
    v_add_u32 v5, 120, v4
    v_cmp_gt_u32 vcc, s46, v5
    s_nop 1
    v_cndmask_b32 v188, 0, v188, vcc
    v_cndmask_b32 v204, 0, v204, vcc
    v_add_u32 v5, 121, v4
    v_cmp_gt_u32 vcc, s46, v5
    s_nop 1
    v_cndmask_b32 v189, 0, v189, vcc
    v_cndmask_b32 v205, 0, v205, vcc
    v_add_u32 v5, 122, v4
    v_cmp_gt_u32 vcc, s46, v5
    s_nop 1
    v_cndmask_b32 v190, 0, v190, vcc
    v_cndmask_b32 v206, 0, v206, vcc
    v_add_u32 v5, 123, v4
    v_cmp_gt_u32 vcc, s46, v5
    s_nop 1
    v_cndmask_b32 v191, 0, v191, vcc
    v_cndmask_b32 v207, 0, v207, vcc
L_k1_noedge:
    v_mov_b32 v208, v80
    v_mul_f32 v209, v80, v80
    v_mov_b32 v210, v81
    v_mul_f32 v211, v81, v81
    v_add_f32 v208, v208, v82
    v_fmac_f32 v209, v82, v82
    v_add_f32 v210, v210, v83
    v_fmac_f32 v211, v83, v83
    v_add_f32 v208, v208, v84
    v_fmac_f32 v209, v84, v84
    v_add_f32 v210, v210, v85
    v_fmac_f32 v211, v85, v85
    v_add_f32 v208, v208, v86
    v_fmac_f32 v209, v86, v86
    v_add_f32 v210, v210, v87
    v_fmac_f32 v211, v87, v87
    v_add_f32 v208, v208, v88
    v_fmac_f32 v209, v88, v88
    v_add_f32 v210, v210, v89
    v_fmac_f32 v211, v89, v89
    v_add_f32 v208, v208, v90
    v_fmac_f32 v209, v90, v90
    v_add_f32 v210, v210, v91
    v_fmac_f32 v211, v91, v91
    v_add_f32 v208, v208, v92
    v_fmac_f32 v209, v92, v92
    v_add_f32 v210, v210, v93
    v_fmac_f32 v211, v93, v93
    v_add_f32 v208, v208, v94
    v_fmac_f32 v209, v94, v94
    v_add_f32 v210, v210, v95
    v_fmac_f32 v211, v95, v95
    v_add_f32 v208, v208, v112
    v_fmac_f32 v209, v112, v112
    v_add_f32 v210, v210, v113
    v_fmac_f32 v211, v113, v113
    v_add_f32 v208, v208, v114
    v_fmac_f32 v209, v114, v114
    v_add_f32 v210, v210, v115
    v_fmac_f32 v211, v115, v115
    v_add_f32 v208, v208, v116
    v_fmac_f32 v209, v116, v116
    v_add_f32 v210, v210, v117
    v_fmac_f32 v211, v117, v117
    v_add_f32 v208, v208, v118
    v_fmac_f32 v209, v118, v118
    v_add_f32 v210, v210, v119
    v_fmac_f32 v211, v119, v119
    v_add_f32 v208, v208, v120
    v_fmac_f32 v209, v120, v120
    v_add_f32 v210, v210, v121
    v_fmac_f32 v211, v121, v121
    v_add_f32 v208, v208, v122
    v_fmac_f32 v209, v122, v122
    v_add_f32 v210, v210, v123
    v_fmac_f32 v211, v123, v123
    v_add_f32 v208, v208, v124
    v_fmac_f32 v209, v124, v124
    v_add_f32 v210, v210, v125
    v_fmac_f32 v211, v125, v125
    v_add_f32 v208, v208, v126
    v_fmac_f32 v209, v126, v126
    v_add_f32 v210, v210, v127
    v_fmac_f32 v211, v127, v127
    v_add_f32 v208, v208, v144
    v_fmac_f32 v209, v144, v144
    v_add_f32 v210, v210, v145
    v_fmac_f32 v211, v145, v145
    v_add_f32 v208, v208, v146
    v_fmac_f32 v209, v146, v146
    v_add_f32 v210, v210, v147
    v_fmac_f32 v211, v147, v147
    v_add_f32 v208, v208, v148
    v_fmac_f32 v209, v148, v148
    v_add_f32 v210, v210, v149
    v_fmac_f32 v211, v149, v149
    v_add_f32 v208, v208, v150
    v_fmac_f32 v209, v150, v150
    v_add_f32 v210, v210, v151
    v_fmac_f32 v211, v151, v151
    v_add_f32 v208, v208, v152
    v_fmac_f32 v209, v152, v152
    v_add_f32 v210, v210, v153
    v_fmac_f32 v211, v153, v153
    v_add_f32 v208, v208, v154
    v_fmac_f32 v209, v154, v154
    v_add_f32 v210, v210, v155
    v_fmac_f32 v211, v155, v155
    v_add_f32 v208, v208, v156
    v_fmac_f32 v209, v156, v156
    v_add_f32 v210, v210, v157
    v_fmac_f32 v211, v157, v157
    v_add_f32 v208, v208, v158
    v_fmac_f32 v209, v158, v158
    v_add_f32 v210, v210, v159
    v_fmac_f32 v211, v159, v159
    v_add_f32 v208, v208, v176
    v_fmac_f32 v209, v176, v176
    v_add_f32 v210, v210, v177
    v_fmac_f32 v211, v177, v177
    v_add_f32 v208, v208, v178
    v_fmac_f32 v209, v178, v178
    v_add_f32 v210, v210, v179
    v_fmac_f32 v211, v179, v179
    v_add_f32 v208, v208, v180
    v_fmac_f32 v209, v180, v180
    v_add_f32 v210, v210, v181
    v_fmac_f32 v211, v181, v181
    v_add_f32 v208, v208, v182
    v_fmac_f32 v209, v182, v182
    v_add_f32 v210, v210, v183
    v_fmac_f32 v211, v183, v183
    v_add_f32 v208, v208, v184
    v_fmac_f32 v209, v184, v184
    v_add_f32 v210, v210, v185
    v_fmac_f32 v211, v185, v185
    v_add_f32 v208, v208, v186
    v_fmac_f32 v209, v186, v186
    v_add_f32 v210, v210, v187
    v_fmac_f32 v211, v187, v187
    v_add_f32 v208, v208, v188
    v_fmac_f32 v209, v188, v188
    v_add_f32 v210, v210, v189
    v_fmac_f32 v211, v189, v189
    v_add_f32 v208, v208, v190
    v_fmac_f32 v209, v190, v190
    v_add_f32 v210, v210, v191
    v_fmac_f32 v211, v191, v191
    v_add_f32 v208, v208, v210
    v_add_f32 v209, v209, v211
    v_mov_b32 v216, v96
    v_mul_f32 v217, v96, v96
    v_mov_b32 v218, v97
    v_mul_f32 v219, v97, v97
    v_add_f32 v216, v216, v98
    v_fmac_f32 v217, v98, v98
    v_add_f32 v218, v218, v99
    v_fmac_f32 v219, v99, v99
    v_add_f32 v216, v216, v100
    v_fmac_f32 v217, v100, v100
    v_add_f32 v218, v218, v101
    v_fmac_f32 v219, v101, v101
    v_add_f32 v216, v216, v102
    v_fmac_f32 v217, v102, v102
    v_add_f32 v218, v218, v103
    v_fmac_f32 v219, v103, v103
    v_add_f32 v216, v216, v104
    v_fmac_f32 v217, v104, v104
    v_add_f32 v218, v218, v105
    v_fmac_f32 v219, v105, v105
    v_add_f32 v216, v216, v106
    v_fmac_f32 v217, v106, v106
    v_add_f32 v218, v218, v107
    v_fmac_f32 v219, v107, v107
    v_add_f32 v216, v216, v108
    v_fmac_f32 v217, v108, v108
    v_add_f32 v218, v218, v109
    v_fmac_f32 v219, v109, v109
    v_add_f32 v216, v216, v110
    v_fmac_f32 v217, v110, v110
    v_add_f32 v218, v218, v111
    v_fmac_f32 v219, v111, v111
    v_add_f32 v216, v216, v128
    v_fmac_f32 v217, v128, v128
    v_add_f32 v218, v218, v129
    v_fmac_f32 v219, v129, v129
    v_add_f32 v216, v216, v130
    v_fmac_f32 v217, v130, v130
    v_add_f32 v218, v218, v131
    v_fmac_f32 v219, v131, v131
    v_add_f32 v216, v216, v132
    v_fmac_f32 v217, v132, v132
    v_add_f32 v218, v218, v133
    v_fmac_f32 v219, v133, v133
    v_add_f32 v216, v216, v134
    v_fmac_f32 v217, v134, v134
    v_add_f32 v218, v218, v135
    v_fmac_f32 v219, v135, v135
    v_add_f32 v216, v216, v136
    v_fmac_f32 v217, v136, v136
    v_add_f32 v218, v218, v137
    v_fmac_f32 v219, v137, v137
    v_add_f32 v216, v216, v138
    v_fmac_f32 v217, v138, v138
    v_add_f32 v218, v218, v139
    v_fmac_f32 v219, v139, v139
    v_add_f32 v216, v216, v140
    v_fmac_f32 v217, v140, v140
    v_add_f32 v218, v218, v141
    v_fmac_f32 v219, v141, v141
    v_add_f32 v216, v216, v142
    v_fmac_f32 v217, v142, v142
    v_add_f32 v218, v218, v143
    v_fmac_f32 v219, v143, v143
    v_add_f32 v216, v216, v160
    v_fmac_f32 v217, v160, v160
    v_add_f32 v218, v218, v161
    v_fmac_f32 v219, v161, v161
    v_add_f32 v216, v216, v162
    v_fmac_f32 v217, v162, v162
    v_add_f32 v218, v218, v163
    v_fmac_f32 v219, v163, v163
    v_add_f32 v216, v216, v164
    v_fmac_f32 v217, v164, v164
    v_add_f32 v218, v218, v165
    v_fmac_f32 v219, v165, v165
    v_add_f32 v216, v216, v166
    v_fmac_f32 v217, v166, v166
    v_add_f32 v218, v218, v167
    v_fmac_f32 v219, v167, v167
    v_add_f32 v216, v216, v168
    v_fmac_f32 v217, v168, v168
    v_add_f32 v218, v218, v169
    v_fmac_f32 v219, v169, v169
    v_add_f32 v216, v216, v170
    v_fmac_f32 v217, v170, v170
    v_add_f32 v218, v218, v171
    v_fmac_f32 v219, v171, v171
    v_add_f32 v216, v216, v172
    v_fmac_f32 v217, v172, v172
    v_add_f32 v218, v218, v173
    v_fmac_f32 v219, v173, v173
    v_add_f32 v216, v216, v174
    v_fmac_f32 v217, v174, v174
    v_add_f32 v218, v218, v175
    v_fmac_f32 v219, v175, v175
    v_add_f32 v216, v216, v192
    v_fmac_f32 v217, v192, v192
    v_add_f32 v218, v218, v193
    v_fmac_f32 v219, v193, v193
    v_add_f32 v216, v216, v194
    v_fmac_f32 v217, v194, v194
    v_add_f32 v218, v218, v195
    v_fmac_f32 v219, v195, v195
    v_add_f32 v216, v216, v196
    v_fmac_f32 v217, v196, v196
    v_add_f32 v218, v218, v197
    v_fmac_f32 v219, v197, v197
    v_add_f32 v216, v216, v198
    v_fmac_f32 v217, v198, v198
    v_add_f32 v218, v218, v199
    v_fmac_f32 v219, v199, v199
    v_add_f32 v216, v216, v200
    v_fmac_f32 v217, v200, v200
    v_add_f32 v218, v218, v201
    v_fmac_f32 v219, v201, v201
    v_add_f32 v216, v216, v202
    v_fmac_f32 v217, v202, v202
    v_add_f32 v218, v218, v203
    v_fmac_f32 v219, v203, v203
    v_add_f32 v216, v216, v204
    v_fmac_f32 v217, v204, v204
    v_add_f32 v218, v218, v205
    v_fmac_f32 v219, v205, v205
    v_add_f32 v216, v216, v206
    v_fmac_f32 v217, v206, v206
    v_add_f32 v218, v218, v207
    v_fmac_f32 v219, v207, v207
    v_add_f32 v216, v216, v218
    v_add_f32 v217, v217, v219
    s_lshl_b32 s3, s17, 7
    s_lshl_b32 s27, s18, 6
    s_add_u32 s3, s3, s27
    v_and_b32 v2, 31, v1
    v_add_u32 v2, s3, v2
    v_lshlrev_b32 v2, 1, v2
    v_add_u32 v2, v2, v3
    v_lshlrev_b32 v2, 3, v2
    ds_write_b64 v2, v[208:209] offset:0
    ds_write_b64 v2, v[216:217] offset:512
    s_waitcnt lgkmcnt(0)
L_k1_sums_done:
    s_barrier
    s_cmp_ge_u32 s16, 2
    s_cbranch_scc1 L_k1_pub_done
    v_lshlrev_b32 v2, 4, v0
    ds_read_b128 v[224:227], v2 offset:0
    ds_read_b128 v[228:231], v2 offset:2048
    s_waitcnt lgkmcnt(0)
    v_add_f32 v208, v224, v226
    v_add_f32 v209, v225, v227
    v_add_f32 v228, v228, v230
    v_add_f32 v229, v229, v231
    v_add_f32 v208, v208, v228
    v_add_f32 v209, v209, v229
    s_lshl_b32 s3, s20, 9
    s_lshl_b32 s27, s19, 7
    s_add_u32 s3, s3, s27
    s_lshl_b32 s3, s3, 3
    s_add_u32 s3, s3, 0
    v_lshlrev_b32 v2, 3, v0
    buffer_store_dwordx2 v[208:209], v2, s[12:15], s3 offen sc1
    s_waitcnt vmcnt(0)
L_k1_pub_done:
    s_barrier
    s_lshl_b32 s47, s21, 2
    s_add_u32 s47, s47, s19
    s_lshl_b32 s47, s47, 5
    s_cmp_lg_u32 s16, 0
    s_cbranch_scc1 L_k1_waited
    v_mov_b32 v2, s47
    v_mov_b32 v5, 1
    s_mov_b64 s[56:57], exec
    s_mov_b64 exec, 1
    global_atomic_add v2, v5, s[54:55] sc1
    s_mov_b32 s58, 0
L_k1_poll:
    global_load_dword v6, v2, s[54:55] sc1
    s_waitcnt vmcnt(0)
    v_readfirstlane_b32 s3, v6
    s_cmp_ge_u32 s3, 32
    s_cbranch_scc1 L_k1_polled
    s_sleep 1
    s_add_u32 s58, s58, 1
    s_cmp_lt_u32 s58, 200000
    s_cbranch_scc1 L_k1_poll
L_k1_polled:
    s_mov_b64 exec, s[56:57]
L_k1_waited:
    s_barrier
    v_lshrrev_b32 v2, 4, v0
    v_and_b32 v5, 15, v0
    v_lshlrev_b32 v6, 12, v2
    v_lshl_add_u32 v6, v5, 6, v6
    s_lshl_b32 s3, s21, 17
    s_lshl_b32 s27, s19, 10
    s_add_u32 s3, s3, s27
    s_add_u32 s3, s3, 0
    buffer_load_dwordx4 v[208:211], v6, s[12:15], s3 offen offset:0 sc1
    buffer_load_dwordx4 v[212:215], v6, s[12:15], s3 offen offset:16 sc1
    buffer_load_dwordx4 v[216:219], v6, s[12:15], s3 offen offset:32 sc1
    buffer_load_dwordx4 v[220:223], v6, s[12:15], s3 offen offset:48 sc1
    v_lshlrev_b32 v7, 10, v2
    v_lshl_add_u32 v7, v5, 6, v7
    s_waitcnt vmcnt(0)
    ds_write_b128 v7, v[208:211] offset:8192
    ds_write_b128 v7, v[212:215] offset:8208
    ds_write_b128 v7, v[216:219] offset:8224
    ds_write_b128 v7, v[220:223] offset:8240
    s_waitcnt lgkmcnt(0)
    s_barrier
    v_and_b32 v5, 127, v0
    v_lshrrev_b32 v2, 7, v0
    v_lshlrev_b32 v7, 13, v2
    v_lshl_add_u32 v7, v5, 3, v7
    ds_read_b64 v[208:209], v7 offset:8192
    ds_read_b64 v[210:211], v7 offset:9216
    ds_read_b64 v[212:213], v7 offset:10240
    ds_read_b64 v[214:215], v7 offset:11264
    ds_read_b64 v[216:217], v7 offset:12288
    ds_read_b64 v[218:219], v7 offset:13312
    ds_read_b64 v[220:221], v7 offset:14336
    ds_read_b64 v[222:223], v7 offset:15360
    s_waitcnt lgkmcnt(0)
    v_add_f32 v208, v208, v210
    v_add_f32 v209, v209, v211
    v_add_f32 v208, v208, v212
    v_add_f32 v209, v209, v213
    v_add_f32 v208, v208, v214
    v_add_f32 v209, v209, v215
    v_add_f32 v208, v208, v216
    v_add_f32 v209, v209, v217
    v_add_f32 v208, v208, v218
    v_add_f32 v209, v209, v219
    v_add_f32 v208, v208, v220
    v_add_f32 v209, v209, v221
    v_add_f32 v208, v208, v222
    v_add_f32 v209, v209, v223
    v_lshlrev_b32 v7, 10, v2
    v_lshl_add_u32 v7, v5, 3, v7
    ds_write_b64 v7, v[208:209] offset:40960
    s_waitcnt lgkmcnt(0)
    s_barrier
    s_lshl_b32 s3, s18, 6
    v_and_b32 v2, 31, v1
    v_add_u32 v2, s3, v2
    v_lshlrev_b32 v2, 3, v2
    ds_read_b64 v[208:209], v2 offset:40960
    ds_read_b64 v[210:211], v2 offset:41984
    ds_read_b64 v[212:213], v2 offset:43008
    ds_read_b64 v[214:215], v2 offset:44032
    ds_read_b64 v[216:217], v2 offset:41216
    ds_read_b64 v[218:219], v2 offset:42240
    ds_read_b64 v[220:221], v2 offset:43264
    ds_read_b64 v[222:223], v2 offset:44288
    s_waitcnt lgkmcnt(0)
    s_mov_b32 s3, 0x39031ad3
    s_mov_b32 s27, 0x3727c5ac
    v_add_f32 v208, v208, v210
    v_add_f32 v209, v209, v211
    v_add_f32 v208, v208, v212
    v_add_f32 v209, v209, v213
    v_add_f32 v208, v208, v214
    v_add_f32 v209, v209, v215
    v_mul_f32 v208, s3, v208
    v_mul_f32 v209, s3, v209
    v_fma_f32 v209, -v208, v208, v209
    v_max_f32 v209, 0, v209
    v_add_f32 v209, s27, v209
    v_rsq_f32 v209, v209
    v_lshlrev_b32 v12, 16, v12
    v_lshlrev_b32 v14, 16, v14
    v_mul_f32 v224, v12, v209
    v_fma_f32 v225, -v208, v224, v14
    v_add_f32 v216, v216, v218
    v_add_f32 v217, v217, v219
    v_add_f32 v216, v216, v220
    v_add_f32 v217, v217, v221
    v_add_f32 v216, v216, v222
    v_add_f32 v217, v217, v223
    v_mul_f32 v216, s3, v216
    v_mul_f32 v217, s3, v217
    v_fma_f32 v217, -v216, v216, v217
    v_max_f32 v217, 0, v217
    v_add_f32 v217, s27, v217
    v_rsq_f32 v217, v217
    v_lshlrev_b32 v13, 16, v13
    v_lshlrev_b32 v15, 16, v15
    v_mul_f32 v226, v13, v217
    v_fma_f32 v227, -v216, v226, v15
    s_cmp_ge_u32 s16, 4
    s_cbranch_scc1 L_k1_end
    s_mul_i32 s3, s21, 7998
    s_lshl_b32 s27, s22, 8
    s_add_u32 s3, s3, s27
    s_lshl_b32 s27, s17, 7
    s_add_u32 s3, s3, s27
    s_lshl_b32 s44, s3, 10
    v_lshlrev_b32 v4, 2, v3
    v_and_b32 v5, 1, v1
    v_add_u32 v4, v4, v5
    v_lshlrev_b32 v8, 10, v4
    s_lshl_b32 s3, s19, 7
    s_lshl_b32 s27, s18, 6
    s_add_u32 s3, s3, s27
    v_and_b32 v6, 30, v1
    v_add_u32 v6, s3, v6
    v_lshlrev_b32 v6, 1, v6
    v_add_u32 v8, v8, v6
    s_lshl_b32 s3, s17, 7
    v_add_u32 v4, s3, v4
    v_mov_b32 v7, 0x05040100
    v_mov_b32 v9, 0x03020706
    v_cmp_eq_u32 vcc, 1, v5
    s_nop 1
    v_cndmask_b32 v7, v7, v9, vcc
    s_mov_b32 s60, 0xbdd2d3e8
    v_mov_b32 v9, 0xc0135761
    v_fma_f32 v80, v80, v224, v225
    v_fma_f32 v81, v81, v224, v225
    v_fma_f32 v82, v82, v224, v225
    v_fma_f32 v83, v83, v224, v225
    v_fma_f32 v84, v84, v224, v225
    v_fma_f32 v85, v85, v224, v225
    v_fma_f32 v86, v86, v224, v225
    v_fma_f32 v87, v87, v224, v225
    v_fma_f32 v88, v88, v224, v225
    v_fma_f32 v89, v89, v224, v225
    v_fma_f32 v90, v90, v224, v225
    v_fma_f32 v91, v91, v224, v225
    v_fma_f32 v92, v92, v224, v225
    v_fma_f32 v93, v93, v224, v225
    v_fma_f32 v94, v94, v224, v225
    v_fma_f32 v95, v95, v224, v225
    v_mul_f32 v16, v80, v80
    v_mul_f32 v17, v81, v81
    v_mul_f32 v18, v82, v82
    v_mul_f32 v19, v83, v83
    v_mul_f32 v20, v84, v84
    v_mul_f32 v21, v85, v85
    v_mul_f32 v22, v86, v86
    v_mul_f32 v23, v87, v87
    v_mul_f32 v24, v88, v88
    v_mul_f32 v25, v89, v89
    v_mul_f32 v26, v90, v90
    v_mul_f32 v27, v91, v91
    v_mul_f32 v28, v92, v92
    v_mul_f32 v29, v93, v93
    v_mul_f32 v30, v94, v94
    v_mul_f32 v31, v95, v95
    v_fma_f32 v16, v16, s60, v9
    v_fma_f32 v17, v17, s60, v9
    v_fma_f32 v18, v18, s60, v9
    v_fma_f32 v19, v19, s60, v9
    v_fma_f32 v20, v20, s60, v9
    v_fma_f32 v21, v21, s60, v9
    v_fma_f32 v22, v22, s60, v9
    v_fma_f32 v23, v23, s60, v9
    v_fma_f32 v24, v24, s60, v9
    v_fma_f32 v25, v25, s60, v9
    v_fma_f32 v26, v26, s60, v9
    v_fma_f32 v27, v27, s60, v9
    v_fma_f32 v28, v28, s60, v9
    v_fma_f32 v29, v29, s60, v9
    v_fma_f32 v30, v30, s60, v9
    v_fma_f32 v31, v31, s60, v9
    v_mul_f32 v16, v16, v80
    v_mul_f32 v17, v17, v81
    v_mul_f32 v18, v18, v82
    v_mul_f32 v19, v19, v83
    v_mul_f32 v20, v20, v84
    v_mul_f32 v21, v21, v85
    v_mul_f32 v22, v22, v86
    v_mul_f32 v23, v23, v87
    v_mul_f32 v24, v24, v88
    v_mul_f32 v25, v25, v89
    v_mul_f32 v26, v26, v90
    v_mul_f32 v27, v27, v91
    v_mul_f32 v28, v28, v92
    v_mul_f32 v29, v29, v93
    v_mul_f32 v30, v30, v94
    v_mul_f32 v31, v31, v95
    v_exp_f32 v16, v16
    v_exp_f32 v17, v17
    v_exp_f32 v18, v18
    v_exp_f32 v19, v19
    v_exp_f32 v20, v20
    v_exp_f32 v21, v21
    v_exp_f32 v22, v22
    v_exp_f32 v23, v23
    v_exp_f32 v24, v24
    v_exp_f32 v25, v25
    v_exp_f32 v26, v26
    v_exp_f32 v27, v27
    v_exp_f32 v28, v28
    v_exp_f32 v29, v29
    v_exp_f32 v30, v30
    v_exp_f32 v31, v31
    v_add_f32 v16, 1.0, v16
    v_add_f32 v17, 1.0, v17
    v_add_f32 v18, 1.0, v18
    v_add_f32 v19, 1.0, v19
    v_add_f32 v20, 1.0, v20
    v_add_f32 v21, 1.0, v21
    v_add_f32 v22, 1.0, v22
    v_add_f32 v23, 1.0, v23
    v_add_f32 v24, 1.0, v24
    v_add_f32 v25, 1.0, v25
    v_add_f32 v26, 1.0, v26
    v_add_f32 v27, 1.0, v27
    v_add_f32 v28, 1.0, v28
    v_add_f32 v29, 1.0, v29
    v_add_f32 v30, 1.0, v30
    v_add_f32 v31, 1.0, v31
    v_rcp_f32 v16, v16
    v_rcp_f32 v17, v17
    v_rcp_f32 v18, v18
    v_rcp_f32 v19, v19
    v_rcp_f32 v20, v20
    v_rcp_f32 v21, v21
    v_rcp_f32 v22, v22
    v_rcp_f32 v23, v23
    v_rcp_f32 v24, v24
    v_rcp_f32 v25, v25
    v_rcp_f32 v26, v26
    v_rcp_f32 v27, v27
    v_rcp_f32 v28, v28
    v_rcp_f32 v29, v29
    v_rcp_f32 v30, v30
    v_rcp_f32 v31, v31
    v_mul_f32 v80, v80, v16
    v_mul_f32 v81, v81, v17
    v_mul_f32 v82, v82, v18
    v_mul_f32 v83, v83, v19
    v_mul_f32 v84, v84, v20
    v_mul_f32 v85, v85, v21
    v_mul_f32 v86, v86, v22
    v_mul_f32 v87, v87, v23
    v_mul_f32 v88, v88, v24
    v_mul_f32 v89, v89, v25
    v_mul_f32 v90, v90, v26
    v_mul_f32 v91, v91, v27
    v_mul_f32 v92, v92, v28
    v_mul_f32 v93, v93, v29
    v_mul_f32 v94, v94, v30
    v_mul_f32 v95, v95, v31
    s_add_u32 s45, s44, 0
    v_cvt_pk_bf16_f32 v32, v80, v81
    s_nop 1
    v_mov_b32_dpp v33, v32 quad_perm:[1,0,3,2] row_mask:0xf bank_mask:0xf
    v_perm_b32 v32, v33, v32, v7
    v_add_u32 v2, 0, v4
    v_cmp_gt_u32 vcc, s46, v2
    s_and_saveexec_b64 s[56:57], vcc
    buffer_store_dword v32, v8, s[64:67], s45 offen offset:0
    s_mov_b64 exec, s[56:57]
    v_cvt_pk_bf16_f32 v34, v82, v83
    s_nop 1
    v_mov_b32_dpp v35, v34 quad_perm:[1,0,3,2] row_mask:0xf bank_mask:0xf
    v_perm_b32 v34, v35, v34, v7
    v_add_u32 v2, 2, v4
    v_cmp_gt_u32 vcc, s46, v2
    s_and_saveexec_b64 s[56:57], vcc
    buffer_store_dword v34, v8, s[64:67], s45 offen offset:2048
    s_mov_b64 exec, s[56:57]
    s_add_u32 s45, s44, 8192
    v_cvt_pk_bf16_f32 v36, v84, v85
    s_nop 1
    v_mov_b32_dpp v37, v36 quad_perm:[1,0,3,2] row_mask:0xf bank_mask:0xf
    v_perm_b32 v36, v37, v36, v7
    v_add_u32 v2, 8, v4
    v_cmp_gt_u32 vcc, s46, v2
    s_and_saveexec_b64 s[56:57], vcc
    buffer_store_dword v36, v8, s[64:67], s45 offen offset:0
    s_mov_b64 exec, s[56:57]
    v_cvt_pk_bf16_f32 v38, v86, v87
    s_nop 1
    v_mov_b32_dpp v39, v38 quad_perm:[1,0,3,2] row_mask:0xf bank_mask:0xf
    v_perm_b32 v38, v39, v38, v7
    v_add_u32 v2, 10, v4
    v_cmp_gt_u32 vcc, s46, v2
    s_and_saveexec_b64 s[56:57], vcc
    buffer_store_dword v38, v8, s[64:67], s45 offen offset:2048
    s_mov_b64 exec, s[56:57]
    s_add_u32 s45, s44, 16384
    v_cvt_pk_bf16_f32 v40, v88, v89
    s_nop 1
    v_mov_b32_dpp v41, v40 quad_perm:[1,0,3,2] row_mask:0xf bank_mask:0xf
    v_perm_b32 v40, v41, v40, v7
    v_add_u32 v2, 16, v4
    v_cmp_gt_u32 vcc, s46, v2
    s_and_saveexec_b64 s[56:57], vcc
    buffer_store_dword v40, v8, s[64:67], s45 offen offset:0
    s_mov_b64 exec, s[56:57]
    v_cvt_pk_bf16_f32 v42, v90, v91
    s_nop 1
    v_mov_b32_dpp v43, v42 quad_perm:[1,0,3,2] row_mask:0xf bank_mask:0xf
    v_perm_b32 v42, v43, v42, v7
    v_add_u32 v2, 18, v4
    v_cmp_gt_u32 vcc, s46, v2
    s_and_saveexec_b64 s[56:57], vcc
    buffer_store_dword v42, v8, s[64:67], s45 offen offset:2048
    s_mov_b64 exec, s[56:57]
    s_add_u32 s45, s44, 24576
    v_cvt_pk_bf16_f32 v44, v92, v93
    s_nop 1
    v_mov_b32_dpp v45, v44 quad_perm:[1,0,3,2] row_mask:0xf bank_mask:0xf
    v_perm_b32 v44, v45, v44, v7
    v_add_u32 v2, 24, v4
    v_cmp_gt_u32 vcc, s46, v2
    s_and_saveexec_b64 s[56:57], vcc
    buffer_store_dword v44, v8, s[64:67], s45 offen offset:0
    s_mov_b64 exec, s[56:57]
    v_cvt_pk_bf16_f32 v46, v94, v95
    s_nop 1
    v_mov_b32_dpp v47, v46 quad_perm:[1,0,3,2] row_mask:0xf bank_mask:0xf
    v_perm_b32 v46, v47, v46, v7
    v_add_u32 v2, 26, v4
    v_cmp_gt_u32 vcc, s46, v2
    s_and_saveexec_b64 s[56:57], vcc
    buffer_store_dword v46, v8, s[64:67], s45 offen offset:2048
    s_mov_b64 exec, s[56:57]
    v_fma_f32 v96, v96, v226, v227
    v_fma_f32 v97, v97, v226, v227
    v_fma_f32 v98, v98, v226, v227
    v_fma_f32 v99, v99, v226, v227
    v_fma_f32 v100, v100, v226, v227
    v_fma_f32 v101, v101, v226, v227
    v_fma_f32 v102, v102, v226, v227
    v_fma_f32 v103, v103, v226, v227
    v_fma_f32 v104, v104, v226, v227
    v_fma_f32 v105, v105, v226, v227
    v_fma_f32 v106, v106, v226, v227
    v_fma_f32 v107, v107, v226, v227
    v_fma_f32 v108, v108, v226, v227
    v_fma_f32 v109, v109, v226, v227
    v_fma_f32 v110, v110, v226, v227
    v_fma_f32 v111, v111, v226, v227
    v_mul_f32 v16, v96, v96
    v_mul_f32 v17, v97, v97
    v_mul_f32 v18, v98, v98
    v_mul_f32 v19, v99, v99
    v_mul_f32 v20, v100, v100
    v_mul_f32 v21, v101, v101
    v_mul_f32 v22, v102, v102
    v_mul_f32 v23, v103, v103
    v_mul_f32 v24, v104, v104
    v_mul_f32 v25, v105, v105
    v_mul_f32 v26, v106, v106
    v_mul_f32 v27, v107, v107
    v_mul_f32 v28, v108, v108
    v_mul_f32 v29, v109, v109
    v_mul_f32 v30, v110, v110
    v_mul_f32 v31, v111, v111
    v_fma_f32 v16, v16, s60, v9
    v_fma_f32 v17, v17, s60, v9
    v_fma_f32 v18, v18, s60, v9
    v_fma_f32 v19, v19, s60, v9
    v_fma_f32 v20, v20, s60, v9
    v_fma_f32 v21, v21, s60, v9
    v_fma_f32 v22, v22, s60, v9
    v_fma_f32 v23, v23, s60, v9
    v_fma_f32 v24, v24, s60, v9
    v_fma_f32 v25, v25, s60, v9
    v_fma_f32 v26, v26, s60, v9
    v_fma_f32 v27, v27, s60, v9
    v_fma_f32 v28, v28, s60, v9
    v_fma_f32 v29, v29, s60, v9
    v_fma_f32 v30, v30, s60, v9
    v_fma_f32 v31, v31, s60, v9
    v_mul_f32 v16, v16, v96
    v_mul_f32 v17, v17, v97
    v_mul_f32 v18, v18, v98
    v_mul_f32 v19, v19, v99
    v_mul_f32 v20, v20, v100
    v_mul_f32 v21, v21, v101
    v_mul_f32 v22, v22, v102
    v_mul_f32 v23, v23, v103
    v_mul_f32 v24, v24, v104
    v_mul_f32 v25, v25, v105
    v_mul_f32 v26, v26, v106
    v_mul_f32 v27, v27, v107
    v_mul_f32 v28, v28, v108
    v_mul_f32 v29, v29, v109
    v_mul_f32 v30, v30, v110
    v_mul_f32 v31, v31, v111
    v_exp_f32 v16, v16
    v_exp_f32 v17, v17
    v_exp_f32 v18, v18
    v_exp_f32 v19, v19
    v_exp_f32 v20, v20
    v_exp_f32 v21, v21
    v_exp_f32 v22, v22
    v_exp_f32 v23, v23
    v_exp_f32 v24, v24
    v_exp_f32 v25, v25
    v_exp_f32 v26, v26
    v_exp_f32 v27, v27
    v_exp_f32 v28, v28
    v_exp_f32 v29, v29
    v_exp_f32 v30, v30
    v_exp_f32 v31, v31
    v_add_f32 v16, 1.0, v16
    v_add_f32 v17, 1.0, v17
    v_add_f32 v18, 1.0, v18
    v_add_f32 v19, 1.0, v19
    v_add_f32 v20, 1.0, v20
    v_add_f32 v21, 1.0, v21
    v_add_f32 v22, 1.0, v22
    v_add_f32 v23, 1.0, v23
    v_add_f32 v24, 1.0, v24
    v_add_f32 v25, 1.0, v25
    v_add_f32 v26, 1.0, v26
    v_add_f32 v27, 1.0, v27
    v_add_f32 v28, 1.0, v28
    v_add_f32 v29, 1.0, v29
    v_add_f32 v30, 1.0, v30
    v_add_f32 v31, 1.0, v31
    v_rcp_f32 v16, v16
    v_rcp_f32 v17, v17
    v_rcp_f32 v18, v18
    v_rcp_f32 v19, v19
    v_rcp_f32 v20, v20
    v_rcp_f32 v21, v21
    v_rcp_f32 v22, v22
    v_rcp_f32 v23, v23
    v_rcp_f32 v24, v24
    v_rcp_f32 v25, v25
    v_rcp_f32 v26, v26
    v_rcp_f32 v27, v27
    v_rcp_f32 v28, v28
    v_rcp_f32 v29, v29
    v_rcp_f32 v30, v30
    v_rcp_f32 v31, v31
    v_mul_f32 v96, v96, v16
    v_mul_f32 v97, v97, v17
    v_mul_f32 v98, v98, v18
    v_mul_f32 v99, v99, v19
    v_mul_f32 v100, v100, v20
    v_mul_f32 v101, v101, v21
    v_mul_f32 v102, v102, v22
    v_mul_f32 v103, v103, v23
    v_mul_f32 v104, v104, v24
    v_mul_f32 v105, v105, v25
    v_mul_f32 v106, v106, v26
    v_mul_f32 v107, v107, v27
    v_mul_f32 v108, v108, v28
    v_mul_f32 v109, v109, v29
    v_mul_f32 v110, v110, v30
    v_mul_f32 v111, v111, v31
    s_add_u32 s45, s44, 0
    v_cvt_pk_bf16_f32 v32, v96, v97
    s_nop 1
    v_mov_b32_dpp v33, v32 quad_perm:[1,0,3,2] row_mask:0xf bank_mask:0xf
    v_perm_b32 v32, v33, v32, v7
    v_add_u32 v2, 0, v4
    v_cmp_gt_u32 vcc, s46, v2
    s_and_saveexec_b64 s[56:57], vcc
    buffer_store_dword v32, v8, s[64:67], s45 offen offset:64
    s_mov_b64 exec, s[56:57]
    v_cvt_pk_bf16_f32 v34, v98, v99
    s_nop 1
    v_mov_b32_dpp v35, v34 quad_perm:[1,0,3,2] row_mask:0xf bank_mask:0xf
    v_perm_b32 v34, v35, v34, v7
    v_add_u32 v2, 2, v4
    v_cmp_gt_u32 vcc, s46, v2
    s_and_saveexec_b64 s[56:57], vcc
    buffer_store_dword v34, v8, s[64:67], s45 offen offset:2112
    s_mov_b64 exec, s[56:57]
    s_add_u32 s45, s44, 8192
    v_cvt_pk_bf16_f32 v36, v100, v101
    s_nop 1
    v_mov_b32_dpp v37, v36 quad_perm:[1,0,3,2] row_mask:0xf bank_mask:0xf
    v_perm_b32 v36, v37, v36, v7
    v_add_u32 v2, 8, v4
    v_cmp_gt_u32 vcc, s46, v2
    s_and_saveexec_b64 s[56:57], vcc
    buffer_store_dword v36, v8, s[64:67], s45 offen offset:64
    s_mov_b64 exec, s[56:57]
    v_cvt_pk_bf16_f32 v38, v102, v103
    s_nop 1
    v_mov_b32_dpp v39, v38 quad_perm:[1,0,3,2] row_mask:0xf bank_mask:0xf
    v_perm_b32 v38, v39, v38, v7
    v_add_u32 v2, 10, v4
    v_cmp_gt_u32 vcc, s46, v2
    s_and_saveexec_b64 s[56:57], vcc
    buffer_store_dword v38, v8, s[64:67], s45 offen offset:2112
    s_mov_b64 exec, s[56:57]
    s_add_u32 s45, s44, 16384
    v_cvt_pk_bf16_f32 v40, v104, v105
    s_nop 1
    v_mov_b32_dpp v41, v40 quad_perm:[1,0,3,2] row_mask:0xf bank_mask:0xf
    v_perm_b32 v40, v41, v40, v7
    v_add_u32 v2, 16, v4
    v_cmp_gt_u32 vcc, s46, v2
    s_and_saveexec_b64 s[56:57], vcc
    buffer_store_dword v40, v8, s[64:67], s45 offen offset:64
    s_mov_b64 exec, s[56:57]
    v_cvt_pk_bf16_f32 v42, v106, v107
    s_nop 1
    v_mov_b32_dpp v43, v42 quad_perm:[1,0,3,2] row_mask:0xf bank_mask:0xf
    v_perm_b32 v42, v43, v42, v7
    v_add_u32 v2, 18, v4
    v_cmp_gt_u32 vcc, s46, v2
    s_and_saveexec_b64 s[56:57], vcc
    buffer_store_dword v42, v8, s[64:67], s45 offen offset:2112
    s_mov_b64 exec, s[56:57]
    s_add_u32 s45, s44, 24576
    v_cvt_pk_bf16_f32 v44, v108, v109
    s_nop 1
    v_mov_b32_dpp v45, v44 quad_perm:[1,0,3,2] row_mask:0xf bank_mask:0xf
    v_perm_b32 v44, v45, v44, v7
    v_add_u32 v2, 24, v4
    v_cmp_gt_u32 vcc, s46, v2
    s_and_saveexec_b64 s[56:57], vcc
    buffer_store_dword v44, v8, s[64:67], s45 offen offset:64
    s_mov_b64 exec, s[56:57]
    v_cvt_pk_bf16_f32 v46, v110, v111
    s_nop 1
    v_mov_b32_dpp v47, v46 quad_perm:[1,0,3,2] row_mask:0xf bank_mask:0xf
    v_perm_b32 v46, v47, v46, v7
    v_add_u32 v2, 26, v4
    v_cmp_gt_u32 vcc, s46, v2
    s_and_saveexec_b64 s[56:57], vcc
    buffer_store_dword v46, v8, s[64:67], s45 offen offset:2112
    s_mov_b64 exec, s[56:57]
    v_fma_f32 v112, v112, v224, v225
    v_fma_f32 v113, v113, v224, v225
    v_fma_f32 v114, v114, v224, v225
    v_fma_f32 v115, v115, v224, v225
    v_fma_f32 v116, v116, v224, v225
    v_fma_f32 v117, v117, v224, v225
    v_fma_f32 v118, v118, v224, v225
    v_fma_f32 v119, v119, v224, v225
    v_fma_f32 v120, v120, v224, v225
    v_fma_f32 v121, v121, v224, v225
    v_fma_f32 v122, v122, v224, v225
    v_fma_f32 v123, v123, v224, v225
    v_fma_f32 v124, v124, v224, v225
    v_fma_f32 v125, v125, v224, v225
    v_fma_f32 v126, v126, v224, v225
    v_fma_f32 v127, v127, v224, v225
    v_mul_f32 v16, v112, v112
    v_mul_f32 v17, v113, v113
    v_mul_f32 v18, v114, v114
    v_mul_f32 v19, v115, v115
    v_mul_f32 v20, v116, v116
    v_mul_f32 v21, v117, v117
    v_mul_f32 v22, v118, v118
    v_mul_f32 v23, v119, v119
    v_mul_f32 v24, v120, v120
    v_mul_f32 v25, v121, v121
    v_mul_f32 v26, v122, v122
    v_mul_f32 v27, v123, v123
    v_mul_f32 v28, v124, v124
    v_mul_f32 v29, v125, v125
    v_mul_f32 v30, v126, v126
    v_mul_f32 v31, v127, v127
    v_fma_f32 v16, v16, s60, v9
    v_fma_f32 v17, v17, s60, v9
    v_fma_f32 v18, v18, s60, v9
    v_fma_f32 v19, v19, s60, v9
    v_fma_f32 v20, v20, s60, v9
    v_fma_f32 v21, v21, s60, v9
    v_fma_f32 v22, v22, s60, v9
    v_fma_f32 v23, v23, s60, v9
    v_fma_f32 v24, v24, s60, v9
    v_fma_f32 v25, v25, s60, v9
    v_fma_f32 v26, v26, s60, v9
    v_fma_f32 v27, v27, s60, v9
    v_fma_f32 v28, v28, s60, v9
    v_fma_f32 v29, v29, s60, v9
    v_fma_f32 v30, v30, s60, v9
    v_fma_f32 v31, v31, s60, v9
    v_mul_f32 v16, v16, v112
    v_mul_f32 v17, v17, v113
    v_mul_f32 v18, v18, v114
    v_mul_f32 v19, v19, v115
    v_mul_f32 v20, v20, v116
    v_mul_f32 v21, v21, v117
    v_mul_f32 v22, v22, v118
    v_mul_f32 v23, v23, v119
    v_mul_f32 v24, v24, v120
    v_mul_f32 v25, v25, v121
    v_mul_f32 v26, v26, v122
    v_mul_f32 v27, v27, v123
    v_mul_f32 v28, v28, v124
    v_mul_f32 v29, v29, v125
    v_mul_f32 v30, v30, v126
    v_mul_f32 v31, v31, v127
    v_exp_f32 v16, v16
    v_exp_f32 v17, v17
    v_exp_f32 v18, v18
    v_exp_f32 v19, v19
    v_exp_f32 v20, v20
    v_exp_f32 v21, v21
    v_exp_f32 v22, v22
    v_exp_f32 v23, v23
    v_exp_f32 v24, v24
    v_exp_f32 v25, v25
    v_exp_f32 v26, v26
    v_exp_f32 v27, v27
    v_exp_f32 v28, v28
    v_exp_f32 v29, v29
    v_exp_f32 v30, v30
    v_exp_f32 v31, v31
    v_add_f32 v16, 1.0, v16
    v_add_f32 v17, 1.0, v17
    v_add_f32 v18, 1.0, v18
    v_add_f32 v19, 1.0, v19
    v_add_f32 v20, 1.0, v20
    v_add_f32 v21, 1.0, v21
    v_add_f32 v22, 1.0, v22
    v_add_f32 v23, 1.0, v23
    v_add_f32 v24, 1.0, v24
    v_add_f32 v25, 1.0, v25
    v_add_f32 v26, 1.0, v26
    v_add_f32 v27, 1.0, v27
    v_add_f32 v28, 1.0, v28
    v_add_f32 v29, 1.0, v29
    v_add_f32 v30, 1.0, v30
    v_add_f32 v31, 1.0, v31
    v_rcp_f32 v16, v16
    v_rcp_f32 v17, v17
    v_rcp_f32 v18, v18
    v_rcp_f32 v19, v19
    v_rcp_f32 v20, v20
    v_rcp_f32 v21, v21
    v_rcp_f32 v22, v22
    v_rcp_f32 v23, v23
    v_rcp_f32 v24, v24
    v_rcp_f32 v25, v25
    v_rcp_f32 v26, v26
    v_rcp_f32 v27, v27
    v_rcp_f32 v28, v28
    v_rcp_f32 v29, v29
    v_rcp_f32 v30, v30
    v_rcp_f32 v31, v31
    v_mul_f32 v112, v112, v16
    v_mul_f32 v113, v113, v17
    v_mul_f32 v114, v114, v18
    v_mul_f32 v115, v115, v19
    v_mul_f32 v116, v116, v20
    v_mul_f32 v117, v117, v21
    v_mul_f32 v118, v118, v22
    v_mul_f32 v119, v119, v23
    v_mul_f32 v120, v120, v24
    v_mul_f32 v121, v121, v25
    v_mul_f32 v122, v122, v26
    v_mul_f32 v123, v123, v27
    v_mul_f32 v124, v124, v28
    v_mul_f32 v125, v125, v29
    v_mul_f32 v126, v126, v30
    v_mul_f32 v127, v127, v31
    s_add_u32 s45, s44, 32768
    v_cvt_pk_bf16_f32 v32, v112, v113
    s_nop 1
    v_mov_b32_dpp v33, v32 quad_perm:[1,0,3,2] row_mask:0xf bank_mask:0xf
    v_perm_b32 v32, v33, v32, v7
    v_add_u32 v2, 32, v4
    v_cmp_gt_u32 vcc, s46, v2
    s_and_saveexec_b64 s[56:57], vcc
    buffer_store_dword v32, v8, s[64:67], s45 offen offset:0
    s_mov_b64 exec, s[56:57]
    v_cvt_pk_bf16_f32 v34, v114, v115
    s_nop 1
    v_mov_b32_dpp v35, v34 quad_perm:[1,0,3,2] row_mask:0xf bank_mask:0xf
    v_perm_b32 v34, v35, v34, v7
    v_add_u32 v2, 34, v4
    v_cmp_gt_u32 vcc, s46, v2
    s_and_saveexec_b64 s[56:57], vcc
    buffer_store_dword v34, v8, s[64:67], s45 offen offset:2048
    s_mov_b64 exec, s[56:57]
    s_add_u32 s45, s44, 40960
    v_cvt_pk_bf16_f32 v36, v116, v117
    s_nop 1
    v_mov_b32_dpp v37, v36 quad_perm:[1,0,3,2] row_mask:0xf bank_mask:0xf
    v_perm_b32 v36, v37, v36, v7
    v_add_u32 v2, 40, v4
    v_cmp_gt_u32 vcc, s46, v2
    s_and_saveexec_b64 s[56:57], vcc
    buffer_store_dword v36, v8, s[64:67], s45 offen offset:0
    s_mov_b64 exec, s[56:57]
    v_cvt_pk_bf16_f32 v38, v118, v119
    s_nop 1
    v_mov_b32_dpp v39, v38 quad_perm:[1,0,3,2] row_mask:0xf bank_mask:0xf
    v_perm_b32 v38, v39, v38, v7
    v_add_u32 v2, 42, v4
    v_cmp_gt_u32 vcc, s46, v2
    s_and_saveexec_b64 s[56:57], vcc
    buffer_store_dword v38, v8, s[64:67], s45 offen offset:2048
    s_mov_b64 exec, s[56:57]
    s_add_u32 s45, s44, 49152
    v_cvt_pk_bf16_f32 v40, v120, v121
    s_nop 1
    v_mov_b32_dpp v41, v40 quad_perm:[1,0,3,2] row_mask:0xf bank_mask:0xf
    v_perm_b32 v40, v41, v40, v7
    v_add_u32 v2, 48, v4
    v_cmp_gt_u32 vcc, s46, v2
    s_and_saveexec_b64 s[56:57], vcc
    buffer_store_dword v40, v8, s[64:67], s45 offen offset:0
    s_mov_b64 exec, s[56:57]
    v_cvt_pk_bf16_f32 v42, v122, v123
    s_nop 1
    v_mov_b32_dpp v43, v42 quad_perm:[1,0,3,2] row_mask:0xf bank_mask:0xf
    v_perm_b32 v42, v43, v42, v7
    v_add_u32 v2, 50, v4
    v_cmp_gt_u32 vcc, s46, v2
    s_and_saveexec_b64 s[56:57], vcc
    buffer_store_dword v42, v8, s[64:67], s45 offen offset:2048
    s_mov_b64 exec, s[56:57]
    s_add_u32 s45, s44, 57344
    v_cvt_pk_bf16_f32 v44, v124, v125
    s_nop 1
    v_mov_b32_dpp v45, v44 quad_perm:[1,0,3,2] row_mask:0xf bank_mask:0xf
    v_perm_b32 v44, v45, v44, v7
    v_add_u32 v2, 56, v4
    v_cmp_gt_u32 vcc, s46, v2
    s_and_saveexec_b64 s[56:57], vcc
    buffer_store_dword v44, v8, s[64:67], s45 offen offset:0
    s_mov_b64 exec, s[56:57]
    v_cvt_pk_bf16_f32 v46, v126, v127
    s_nop 1
    v_mov_b32_dpp v47, v46 quad_perm:[1,0,3,2] row_mask:0xf bank_mask:0xf
    v_perm_b32 v46, v47, v46, v7
    v_add_u32 v2, 58, v4
    v_cmp_gt_u32 vcc, s46, v2
    s_and_saveexec_b64 s[56:57], vcc
    buffer_store_dword v46, v8, s[64:67], s45 offen offset:2048
    s_mov_b64 exec, s[56:57]
    v_fma_f32 v128, v128, v226, v227
    v_fma_f32 v129, v129, v226, v227
    v_fma_f32 v130, v130, v226, v227
    v_fma_f32 v131, v131, v226, v227
    v_fma_f32 v132, v132, v226, v227
    v_fma_f32 v133, v133, v226, v227
    v_fma_f32 v134, v134, v226, v227
    v_fma_f32 v135, v135, v226, v227
    v_fma_f32 v136, v136, v226, v227
    v_fma_f32 v137, v137, v226, v227
    v_fma_f32 v138, v138, v226, v227
    v_fma_f32 v139, v139, v226, v227
    v_fma_f32 v140, v140, v226, v227
    v_fma_f32 v141, v141, v226, v227
    v_fma_f32 v142, v142, v226, v227
    v_fma_f32 v143, v143, v226, v227
    v_mul_f32 v16, v128, v128
    v_mul_f32 v17, v129, v129
    v_mul_f32 v18, v130, v130
    v_mul_f32 v19, v131, v131
    v_mul_f32 v20, v132, v132
    v_mul_f32 v21, v133, v133
    v_mul_f32 v22, v134, v134
    v_mul_f32 v23, v135, v135
    v_mul_f32 v24, v136, v136
    v_mul_f32 v25, v137, v137
    v_mul_f32 v26, v138, v138
    v_mul_f32 v27, v139, v139
    v_mul_f32 v28, v140, v140
    v_mul_f32 v29, v141, v141
    v_mul_f32 v30, v142, v142
    v_mul_f32 v31, v143, v143
    v_fma_f32 v16, v16, s60, v9
    v_fma_f32 v17, v17, s60, v9
    v_fma_f32 v18, v18, s60, v9
    v_fma_f32 v19, v19, s60, v9
    v_fma_f32 v20, v20, s60, v9
    v_fma_f32 v21, v21, s60, v9
    v_fma_f32 v22, v22, s60, v9
    v_fma_f32 v23, v23, s60, v9
    v_fma_f32 v24, v24, s60, v9
    v_fma_f32 v25, v25, s60, v9
    v_fma_f32 v26, v26, s60, v9
    v_fma_f32 v27, v27, s60, v9
    v_fma_f32 v28, v28, s60, v9
    v_fma_f32 v29, v29, s60, v9
    v_fma_f32 v30, v30, s60, v9
    v_fma_f32 v31, v31, s60, v9
    v_mul_f32 v16, v16, v128
    v_mul_f32 v17, v17, v129
    v_mul_f32 v18, v18, v130
    v_mul_f32 v19, v19, v131
    v_mul_f32 v20, v20, v132
    v_mul_f32 v21, v21, v133
    v_mul_f32 v22, v22, v134
    v_mul_f32 v23, v23, v135
    v_mul_f32 v24, v24, v136
    v_mul_f32 v25, v25, v137
    v_mul_f32 v26, v26, v138
    v_mul_f32 v27, v27, v139
    v_mul_f32 v28, v28, v140
    v_mul_f32 v29, v29, v141
    v_mul_f32 v30, v30, v142
    v_mul_f32 v31, v31, v143
    v_exp_f32 v16, v16
    v_exp_f32 v17, v17
    v_exp_f32 v18, v18
    v_exp_f32 v19, v19
    v_exp_f32 v20, v20
    v_exp_f32 v21, v21
    v_exp_f32 v22, v22
    v_exp_f32 v23, v23
    v_exp_f32 v24, v24
    v_exp_f32 v25, v25
    v_exp_f32 v26, v26
    v_exp_f32 v27, v27
    v_exp_f32 v28, v28
    v_exp_f32 v29, v29
    v_exp_f32 v30, v30
    v_exp_f32 v31, v31
    v_add_f32 v16, 1.0, v16
    v_add_f32 v17, 1.0, v17
    v_add_f32 v18, 1.0, v18
    v_add_f32 v19, 1.0, v19
    v_add_f32 v20, 1.0, v20
    v_add_f32 v21, 1.0, v21
    v_add_f32 v22, 1.0, v22
    v_add_f32 v23, 1.0, v23
    v_add_f32 v24, 1.0, v24
    v_add_f32 v25, 1.0, v25
    v_add_f32 v26, 1.0, v26
    v_add_f32 v27, 1.0, v27
    v_add_f32 v28, 1.0, v28
    v_add_f32 v29, 1.0, v29
    v_add_f32 v30, 1.0, v30
    v_add_f32 v31, 1.0, v31
    v_rcp_f32 v16, v16
    v_rcp_f32 v17, v17
    v_rcp_f32 v18, v18
    v_rcp_f32 v19, v19
    v_rcp_f32 v20, v20
    v_rcp_f32 v21, v21
    v_rcp_f32 v22, v22
    v_rcp_f32 v23, v23
    v_rcp_f32 v24, v24
    v_rcp_f32 v25, v25
    v_rcp_f32 v26, v26
    v_rcp_f32 v27, v27
    v_rcp_f32 v28, v28
    v_rcp_f32 v29, v29
    v_rcp_f32 v30, v30
    v_rcp_f32 v31, v31
    v_mul_f32 v128, v128, v16
    v_mul_f32 v129, v129, v17
    v_mul_f32 v130, v130, v18
    v_mul_f32 v131, v131, v19
    v_mul_f32 v132, v132, v20
    v_mul_f32 v133, v133, v21
    v_mul_f32 v134, v134, v22
    v_mul_f32 v135, v135, v23
    v_mul_f32 v136, v136, v24
    v_mul_f32 v137, v137, v25
    v_mul_f32 v138, v138, v26
    v_mul_f32 v139, v139, v27
    v_mul_f32 v140, v140, v28
    v_mul_f32 v141, v141, v29
    v_mul_f32 v142, v142, v30
    v_mul_f32 v143, v143, v31
    s_add_u32 s45, s44, 32768
    v_cvt_pk_bf16_f32 v32, v128, v129
    s_nop 1
    v_mov_b32_dpp v33, v32 quad_perm:[1,0,3,2] row_mask:0xf bank_mask:0xf
    v_perm_b32 v32, v33, v32, v7
    v_add_u32 v2, 32, v4
    v_cmp_gt_u32 vcc, s46, v2
    s_and_saveexec_b64 s[56:57], vcc
    buffer_store_dword v32, v8, s[64:67], s45 offen offset:64
    s_mov_b64 exec, s[56:57]
    v_cvt_pk_bf16_f32 v34, v130, v131
    s_nop 1
    v_mov_b32_dpp v35, v34 quad_perm:[1,0,3,2] row_mask:0xf bank_mask:0xf
    v_perm_b32 v34, v35, v34, v7
    v_add_u32 v2, 34, v4
    v_cmp_gt_u32 vcc, s46, v2
    s_and_saveexec_b64 s[56:57], vcc
    buffer_store_dword v34, v8, s[64:67], s45 offen offset:2112
    s_mov_b64 exec, s[56:57]
    s_add_u32 s45, s44, 40960
    v_cvt_pk_bf16_f32 v36, v132, v133
    s_nop 1
    v_mov_b32_dpp v37, v36 quad_perm:[1,0,3,2] row_mask:0xf bank_mask:0xf
    v_perm_b32 v36, v37, v36, v7
    v_add_u32 v2, 40, v4
    v_cmp_gt_u32 vcc, s46, v2
    s_and_saveexec_b64 s[56:57], vcc
    buffer_store_dword v36, v8, s[64:67], s45 offen offset:64
    s_mov_b64 exec, s[56:57]
    v_cvt_pk_bf16_f32 v38, v134, v135
    s_nop 1
    v_mov_b32_dpp v39, v38 quad_perm:[1,0,3,2] row_mask:0xf bank_mask:0xf
    v_perm_b32 v38, v39, v38, v7
    v_add_u32 v2, 42, v4
    v_cmp_gt_u32 vcc, s46, v2
    s_and_saveexec_b64 s[56:57], vcc
    buffer_store_dword v38, v8, s[64:67], s45 offen offset:2112
    s_mov_b64 exec, s[56:57]
    s_add_u32 s45, s44, 49152
    v_cvt_pk_bf16_f32 v40, v136, v137
    s_nop 1
    v_mov_b32_dpp v41, v40 quad_perm:[1,0,3,2] row_mask:0xf bank_mask:0xf
    v_perm_b32 v40, v41, v40, v7
    v_add_u32 v2, 48, v4
    v_cmp_gt_u32 vcc, s46, v2
    s_and_saveexec_b64 s[56:57], vcc
    buffer_store_dword v40, v8, s[64:67], s45 offen offset:64
    s_mov_b64 exec, s[56:57]
    v_cvt_pk_bf16_f32 v42, v138, v139
    s_nop 1
    v_mov_b32_dpp v43, v42 quad_perm:[1,0,3,2] row_mask:0xf bank_mask:0xf
    v_perm_b32 v42, v43, v42, v7
    v_add_u32 v2, 50, v4
    v_cmp_gt_u32 vcc, s46, v2
    s_and_saveexec_b64 s[56:57], vcc
    buffer_store_dword v42, v8, s[64:67], s45 offen offset:2112
    s_mov_b64 exec, s[56:57]
    s_add_u32 s45, s44, 57344
    v_cvt_pk_bf16_f32 v44, v140, v141
    s_nop 1
    v_mov_b32_dpp v45, v44 quad_perm:[1,0,3,2] row_mask:0xf bank_mask:0xf
    v_perm_b32 v44, v45, v44, v7
    v_add_u32 v2, 56, v4
    v_cmp_gt_u32 vcc, s46, v2
    s_and_saveexec_b64 s[56:57], vcc
    buffer_store_dword v44, v8, s[64:67], s45 offen offset:64
    s_mov_b64 exec, s[56:57]
    v_cvt_pk_bf16_f32 v46, v142, v143
    s_nop 1
    v_mov_b32_dpp v47, v46 quad_perm:[1,0,3,2] row_mask:0xf bank_mask:0xf
    v_perm_b32 v46, v47, v46, v7
    v_add_u32 v2, 58, v4
    v_cmp_gt_u32 vcc, s46, v2
    s_and_saveexec_b64 s[56:57], vcc
    buffer_store_dword v46, v8, s[64:67], s45 offen offset:2112
    s_mov_b64 exec, s[56:57]
    v_fma_f32 v144, v144, v224, v225
    v_fma_f32 v145, v145, v224, v225
    v_fma_f32 v146, v146, v224, v225
    v_fma_f32 v147, v147, v224, v225
    v_fma_f32 v148, v148, v224, v225
    v_fma_f32 v149, v149, v224, v225
    v_fma_f32 v150, v150, v224, v225
    v_fma_f32 v151, v151, v224, v225
    v_fma_f32 v152, v152, v224, v225
    v_fma_f32 v153, v153, v224, v225
    v_fma_f32 v154, v154, v224, v225
    v_fma_f32 v155, v155, v224, v225
    v_fma_f32 v156, v156, v224, v225
    v_fma_f32 v157, v157, v224, v225
    v_fma_f32 v158, v158, v224, v225
    v_fma_f32 v159, v159, v224, v225
    v_mul_f32 v16, v144, v144
    v_mul_f32 v17, v145, v145
    v_mul_f32 v18, v146, v146
    v_mul_f32 v19, v147, v147
    v_mul_f32 v20, v148, v148
    v_mul_f32 v21, v149, v149
    v_mul_f32 v22, v150, v150
    v_mul_f32 v23, v151, v151
    v_mul_f32 v24, v152, v152
    v_mul_f32 v25, v153, v153
    v_mul_f32 v26, v154, v154
    v_mul_f32 v27, v155, v155
    v_mul_f32 v28, v156, v156
    v_mul_f32 v29, v157, v157
    v_mul_f32 v30, v158, v158
    v_mul_f32 v31, v159, v159
    v_fma_f32 v16, v16, s60, v9
    v_fma_f32 v17, v17, s60, v9
    v_fma_f32 v18, v18, s60, v9
    v_fma_f32 v19, v19, s60, v9
    v_fma_f32 v20, v20, s60, v9
    v_fma_f32 v21, v21, s60, v9
    v_fma_f32 v22, v22, s60, v9
    v_fma_f32 v23, v23, s60, v9
    v_fma_f32 v24, v24, s60, v9
    v_fma_f32 v25, v25, s60, v9
    v_fma_f32 v26, v26, s60, v9
    v_fma_f32 v27, v27, s60, v9
    v_fma_f32 v28, v28, s60, v9
    v_fma_f32 v29, v29, s60, v9
    v_fma_f32 v30, v30, s60, v9
    v_fma_f32 v31, v31, s60, v9
    v_mul_f32 v16, v16, v144
    v_mul_f32 v17, v17, v145
    v_mul_f32 v18, v18, v146
    v_mul_f32 v19, v19, v147
    v_mul_f32 v20, v20, v148
    v_mul_f32 v21, v21, v149
    v_mul_f32 v22, v22, v150
    v_mul_f32 v23, v23, v151
    v_mul_f32 v24, v24, v152
    v_mul_f32 v25, v25, v153
    v_mul_f32 v26, v26, v154
    v_mul_f32 v27, v27, v155
    v_mul_f32 v28, v28, v156
    v_mul_f32 v29, v29, v157
    v_mul_f32 v30, v30, v158
    v_mul_f32 v31, v31, v159
    v_exp_f32 v16, v16
    v_exp_f32 v17, v17
    v_exp_f32 v18, v18
    v_exp_f32 v19, v19
    v_exp_f32 v20, v20
    v_exp_f32 v21, v21
    v_exp_f32 v22, v22
    v_exp_f32 v23, v23
    v_exp_f32 v24, v24
    v_exp_f32 v25, v25
    v_exp_f32 v26, v26
    v_exp_f32 v27, v27
    v_exp_f32 v28, v28
    v_exp_f32 v29, v29
    v_exp_f32 v30, v30
    v_exp_f32 v31, v31
    v_add_f32 v16, 1.0, v16
    v_add_f32 v17, 1.0, v17
    v_add_f32 v18, 1.0, v18
    v_add_f32 v19, 1.0, v19
    v_add_f32 v20, 1.0, v20
    v_add_f32 v21, 1.0, v21
    v_add_f32 v22, 1.0, v22
    v_add_f32 v23, 1.0, v23
    v_add_f32 v24, 1.0, v24
    v_add_f32 v25, 1.0, v25
    v_add_f32 v26, 1.0, v26
    v_add_f32 v27, 1.0, v27
    v_add_f32 v28, 1.0, v28
    v_add_f32 v29, 1.0, v29
    v_add_f32 v30, 1.0, v30
    v_add_f32 v31, 1.0, v31
    v_rcp_f32 v16, v16
    v_rcp_f32 v17, v17
    v_rcp_f32 v18, v18
    v_rcp_f32 v19, v19
    v_rcp_f32 v20, v20
    v_rcp_f32 v21, v21
    v_rcp_f32 v22, v22
    v_rcp_f32 v23, v23
    v_rcp_f32 v24, v24
    v_rcp_f32 v25, v25
    v_rcp_f32 v26, v26
    v_rcp_f32 v27, v27
    v_rcp_f32 v28, v28
    v_rcp_f32 v29, v29
    v_rcp_f32 v30, v30
    v_rcp_f32 v31, v31
    v_mul_f32 v144, v144, v16
    v_mul_f32 v145, v145, v17
    v_mul_f32 v146, v146, v18
    v_mul_f32 v147, v147, v19
    v_mul_f32 v148, v148, v20
    v_mul_f32 v149, v149, v21
    v_mul_f32 v150, v150, v22
    v_mul_f32 v151, v151, v23
    v_mul_f32 v152, v152, v24
    v_mul_f32 v153, v153, v25
    v_mul_f32 v154, v154, v26
    v_mul_f32 v155, v155, v27
    v_mul_f32 v156, v156, v28
    v_mul_f32 v157, v157, v29
    v_mul_f32 v158, v158, v30
    v_mul_f32 v159, v159, v31
    s_add_u32 s45, s44, 65536
    v_cvt_pk_bf16_f32 v32, v144, v145
    s_nop 1
    v_mov_b32_dpp v33, v32 quad_perm:[1,0,3,2] row_mask:0xf bank_mask:0xf
    v_perm_b32 v32, v33, v32, v7
    v_add_u32 v2, 64, v4
    v_cmp_gt_u32 vcc, s46, v2
    s_and_saveexec_b64 s[56:57], vcc
    buffer_store_dword v32, v8, s[64:67], s45 offen offset:0
    s_mov_b64 exec, s[56:57]
    v_cvt_pk_bf16_f32 v34, v146, v147
    s_nop 1
    v_mov_b32_dpp v35, v34 quad_perm:[1,0,3,2] row_mask:0xf bank_mask:0xf
    v_perm_b32 v34, v35, v34, v7
    v_add_u32 v2, 66, v4
    v_cmp_gt_u32 vcc, s46, v2
    s_and_saveexec_b64 s[56:57], vcc
    buffer_store_dword v34, v8, s[64:67], s45 offen offset:2048
    s_mov_b64 exec, s[56:57]
    s_add_u32 s45, s44, 73728
    v_cvt_pk_bf16_f32 v36, v148, v149
    s_nop 1
    v_mov_b32_dpp v37, v36 quad_perm:[1,0,3,2] row_mask:0xf bank_mask:0xf
    v_perm_b32 v36, v37, v36, v7
    v_add_u32 v2, 72, v4
    v_cmp_gt_u32 vcc, s46, v2
    s_and_saveexec_b64 s[56:57], vcc
    buffer_store_dword v36, v8, s[64:67], s45 offen offset:0
    s_mov_b64 exec, s[56:57]
    v_cvt_pk_bf16_f32 v38, v150, v151
    s_nop 1
    v_mov_b32_dpp v39, v38 quad_perm:[1,0,3,2] row_mask:0xf bank_mask:0xf
    v_perm_b32 v38, v39, v38, v7
    v_add_u32 v2, 74, v4
    v_cmp_gt_u32 vcc, s46, v2
    s_and_saveexec_b64 s[56:57], vcc
    buffer_store_dword v38, v8, s[64:67], s45 offen offset:2048
    s_mov_b64 exec, s[56:57]
    s_add_u32 s45, s44, 81920
    v_cvt_pk_bf16_f32 v40, v152, v153
    s_nop 1
    v_mov_b32_dpp v41, v40 quad_perm:[1,0,3,2] row_mask:0xf bank_mask:0xf
    v_perm_b32 v40, v41, v40, v7
    v_add_u32 v2, 80, v4
    v_cmp_gt_u32 vcc, s46, v2
    s_and_saveexec_b64 s[56:57], vcc
    buffer_store_dword v40, v8, s[64:67], s45 offen offset:0
    s_mov_b64 exec, s[56:57]
    v_cvt_pk_bf16_f32 v42, v154, v155
    s_nop 1
    v_mov_b32_dpp v43, v42 quad_perm:[1,0,3,2] row_mask:0xf bank_mask:0xf
    v_perm_b32 v42, v43, v42, v7
    v_add_u32 v2, 82, v4
    v_cmp_gt_u32 vcc, s46, v2
    s_and_saveexec_b64 s[56:57], vcc
    buffer_store_dword v42, v8, s[64:67], s45 offen offset:2048
    s_mov_b64 exec, s[56:57]
    s_add_u32 s45, s44, 90112
    v_cvt_pk_bf16_f32 v44, v156, v157
    s_nop 1
    v_mov_b32_dpp v45, v44 quad_perm:[1,0,3,2] row_mask:0xf bank_mask:0xf
    v_perm_b32 v44, v45, v44, v7
    v_add_u32 v2, 88, v4
    v_cmp_gt_u32 vcc, s46, v2
    s_and_saveexec_b64 s[56:57], vcc
    buffer_store_dword v44, v8, s[64:67], s45 offen offset:0
    s_mov_b64 exec, s[56:57]
    v_cvt_pk_bf16_f32 v46, v158, v159
    s_nop 1
    v_mov_b32_dpp v47, v46 quad_perm:[1,0,3,2] row_mask:0xf bank_mask:0xf
    v_perm_b32 v46, v47, v46, v7
    v_add_u32 v2, 90, v4
    v_cmp_gt_u32 vcc, s46, v2
    s_and_saveexec_b64 s[56:57], vcc
    buffer_store_dword v46, v8, s[64:67], s45 offen offset:2048
    s_mov_b64 exec, s[56:57]
    v_fma_f32 v160, v160, v226, v227
    v_fma_f32 v161, v161, v226, v227
    v_fma_f32 v162, v162, v226, v227
    v_fma_f32 v163, v163, v226, v227
    v_fma_f32 v164, v164, v226, v227
    v_fma_f32 v165, v165, v226, v227
    v_fma_f32 v166, v166, v226, v227
    v_fma_f32 v167, v167, v226, v227
    v_fma_f32 v168, v168, v226, v227
    v_fma_f32 v169, v169, v226, v227
    v_fma_f32 v170, v170, v226, v227
    v_fma_f32 v171, v171, v226, v227
    v_fma_f32 v172, v172, v226, v227
    v_fma_f32 v173, v173, v226, v227
    v_fma_f32 v174, v174, v226, v227
    v_fma_f32 v175, v175, v226, v227
    v_mul_f32 v16, v160, v160
    v_mul_f32 v17, v161, v161
    v_mul_f32 v18, v162, v162
    v_mul_f32 v19, v163, v163
    v_mul_f32 v20, v164, v164
    v_mul_f32 v21, v165, v165
    v_mul_f32 v22, v166, v166
    v_mul_f32 v23, v167, v167
    v_mul_f32 v24, v168, v168
    v_mul_f32 v25, v169, v169
    v_mul_f32 v26, v170, v170
    v_mul_f32 v27, v171, v171
    v_mul_f32 v28, v172, v172
    v_mul_f32 v29, v173, v173
    v_mul_f32 v30, v174, v174
    v_mul_f32 v31, v175, v175
    v_fma_f32 v16, v16, s60, v9
    v_fma_f32 v17, v17, s60, v9
    v_fma_f32 v18, v18, s60, v9
    v_fma_f32 v19, v19, s60, v9
    v_fma_f32 v20, v20, s60, v9
    v_fma_f32 v21, v21, s60, v9
    v_fma_f32 v22, v22, s60, v9
    v_fma_f32 v23, v23, s60, v9
    v_fma_f32 v24, v24, s60, v9
    v_fma_f32 v25, v25, s60, v9
    v_fma_f32 v26, v26, s60, v9
    v_fma_f32 v27, v27, s60, v9
    v_fma_f32 v28, v28, s60, v9
    v_fma_f32 v29, v29, s60, v9
    v_fma_f32 v30, v30, s60, v9
    v_fma_f32 v31, v31, s60, v9
    v_mul_f32 v16, v16, v160
    v_mul_f32 v17, v17, v161
    v_mul_f32 v18, v18, v162
    v_mul_f32 v19, v19, v163
    v_mul_f32 v20, v20, v164
    v_mul_f32 v21, v21, v165
    v_mul_f32 v22, v22, v166
    v_mul_f32 v23, v23, v167
    v_mul_f32 v24, v24, v168
    v_mul_f32 v25, v25, v169
    v_mul_f32 v26, v26, v170
    v_mul_f32 v27, v27, v171
    v_mul_f32 v28, v28, v172
    v_mul_f32 v29, v29, v173
    v_mul_f32 v30, v30, v174
    v_mul_f32 v31, v31, v175
    v_exp_f32 v16, v16
    v_exp_f32 v17, v17
    v_exp_f32 v18, v18
    v_exp_f32 v19, v19
    v_exp_f32 v20, v20
    v_exp_f32 v21, v21
    v_exp_f32 v22, v22
    v_exp_f32 v23, v23
    v_exp_f32 v24, v24
    v_exp_f32 v25, v25
    v_exp_f32 v26, v26
    v_exp_f32 v27, v27
    v_exp_f32 v28, v28
    v_exp_f32 v29, v29
    v_exp_f32 v30, v30
    v_exp_f32 v31, v31
    v_add_f32 v16, 1.0, v16
    v_add_f32 v17, 1.0, v17
    v_add_f32 v18, 1.0, v18
    v_add_f32 v19, 1.0, v19
    v_add_f32 v20, 1.0, v20
    v_add_f32 v21, 1.0, v21
    v_add_f32 v22, 1.0, v22
    v_add_f32 v23, 1.0, v23
    v_add_f32 v24, 1.0, v24
    v_add_f32 v25, 1.0, v25
    v_add_f32 v26, 1.0, v26
    v_add_f32 v27, 1.0, v27
    v_add_f32 v28, 1.0, v28
    v_add_f32 v29, 1.0, v29
    v_add_f32 v30, 1.0, v30
    v_add_f32 v31, 1.0, v31
    v_rcp_f32 v16, v16
    v_rcp_f32 v17, v17
    v_rcp_f32 v18, v18
    v_rcp_f32 v19, v19
    v_rcp_f32 v20, v20
    v_rcp_f32 v21, v21
    v_rcp_f32 v22, v22
    v_rcp_f32 v23, v23
    v_rcp_f32 v24, v24
    v_rcp_f32 v25, v25
    v_rcp_f32 v26, v26
    v_rcp_f32 v27, v27
    v_rcp_f32 v28, v28
    v_rcp_f32 v29, v29
    v_rcp_f32 v30, v30
    v_rcp_f32 v31, v31
    v_mul_f32 v160, v160, v16
    v_mul_f32 v161, v161, v17
    v_mul_f32 v162, v162, v18
    v_mul_f32 v163, v163, v19
    v_mul_f32 v164, v164, v20
    v_mul_f32 v165, v165, v21
    v_mul_f32 v166, v166, v22
    v_mul_f32 v167, v167, v23
    v_mul_f32 v168, v168, v24
    v_mul_f32 v169, v169, v25
    v_mul_f32 v170, v170, v26
    v_mul_f32 v171, v171, v27
    v_mul_f32 v172, v172, v28
    v_mul_f32 v173, v173, v29
    v_mul_f32 v174, v174, v30
    v_mul_f32 v175, v175, v31
    s_add_u32 s45, s44, 65536
    v_cvt_pk_bf16_f32 v32, v160, v161
    s_nop 1
    v_mov_b32_dpp v33, v32 quad_perm:[1,0,3,2] row_mask:0xf bank_mask:0xf
    v_perm_b32 v32, v33, v32, v7
    v_add_u32 v2, 64, v4
    v_cmp_gt_u32 vcc, s46, v2
    s_and_saveexec_b64 s[56:57], vcc
    buffer_store_dword v32, v8, s[64:67], s45 offen offset:64
    s_mov_b64 exec, s[56:57]
    v_cvt_pk_bf16_f32 v34, v162, v163
    s_nop 1
    v_mov_b32_dpp v35, v34 quad_perm:[1,0,3,2] row_mask:0xf bank_mask:0xf
    v_perm_b32 v34, v35, v34, v7
    v_add_u32 v2, 66, v4
    v_cmp_gt_u32 vcc, s46, v2
    s_and_saveexec_b64 s[56:57], vcc
    buffer_store_dword v34, v8, s[64:67], s45 offen offset:2112
    s_mov_b64 exec, s[56:57]
    s_add_u32 s45, s44, 73728
    v_cvt_pk_bf16_f32 v36, v164, v165
    s_nop 1
    v_mov_b32_dpp v37, v36 quad_perm:[1,0,3,2] row_mask:0xf bank_mask:0xf
    v_perm_b32 v36, v37, v36, v7
    v_add_u32 v2, 72, v4
    v_cmp_gt_u32 vcc, s46, v2
    s_and_saveexec_b64 s[56:57], vcc
    buffer_store_dword v36, v8, s[64:67], s45 offen offset:64
    s_mov_b64 exec, s[56:57]
    v_cvt_pk_bf16_f32 v38, v166, v167
    s_nop 1
    v_mov_b32_dpp v39, v38 quad_perm:[1,0,3,2] row_mask:0xf bank_mask:0xf
    v_perm_b32 v38, v39, v38, v7
    v_add_u32 v2, 74, v4
    v_cmp_gt_u32 vcc, s46, v2
    s_and_saveexec_b64 s[56:57], vcc
    buffer_store_dword v38, v8, s[64:67], s45 offen offset:2112
    s_mov_b64 exec, s[56:57]
    s_add_u32 s45, s44, 81920
    v_cvt_pk_bf16_f32 v40, v168, v169
    s_nop 1
    v_mov_b32_dpp v41, v40 quad_perm:[1,0,3,2] row_mask:0xf bank_mask:0xf
    v_perm_b32 v40, v41, v40, v7
    v_add_u32 v2, 80, v4
    v_cmp_gt_u32 vcc, s46, v2
    s_and_saveexec_b64 s[56:57], vcc
    buffer_store_dword v40, v8, s[64:67], s45 offen offset:64
    s_mov_b64 exec, s[56:57]
    v_cvt_pk_bf16_f32 v42, v170, v171
    s_nop 1
    v_mov_b32_dpp v43, v42 quad_perm:[1,0,3,2] row_mask:0xf bank_mask:0xf
    v_perm_b32 v42, v43, v42, v7
    v_add_u32 v2, 82, v4
    v_cmp_gt_u32 vcc, s46, v2
    s_and_saveexec_b64 s[56:57], vcc
    buffer_store_dword v42, v8, s[64:67], s45 offen offset:2112
    s_mov_b64 exec, s[56:57]
    s_add_u32 s45, s44, 90112
    v_cvt_pk_bf16_f32 v44, v172, v173
    s_nop 1
    v_mov_b32_dpp v45, v44 quad_perm:[1,0,3,2] row_mask:0xf bank_mask:0xf
    v_perm_b32 v44, v45, v44, v7
    v_add_u32 v2, 88, v4
    v_cmp_gt_u32 vcc, s46, v2
    s_and_saveexec_b64 s[56:57], vcc
    buffer_store_dword v44, v8, s[64:67], s45 offen offset:64
    s_mov_b64 exec, s[56:57]
    v_cvt_pk_bf16_f32 v46, v174, v175
    s_nop 1
    v_mov_b32_dpp v47, v46 quad_perm:[1,0,3,2] row_mask:0xf bank_mask:0xf
    v_perm_b32 v46, v47, v46, v7
    v_add_u32 v2, 90, v4
    v_cmp_gt_u32 vcc, s46, v2
    s_and_saveexec_b64 s[56:57], vcc
    buffer_store_dword v46, v8, s[64:67], s45 offen offset:2112
    s_mov_b64 exec, s[56:57]
    v_fma_f32 v176, v176, v224, v225
    v_fma_f32 v177, v177, v224, v225
    v_fma_f32 v178, v178, v224, v225
    v_fma_f32 v179, v179, v224, v225
    v_fma_f32 v180, v180, v224, v225
    v_fma_f32 v181, v181, v224, v225
    v_fma_f32 v182, v182, v224, v225
    v_fma_f32 v183, v183, v224, v225
    v_fma_f32 v184, v184, v224, v225
    v_fma_f32 v185, v185, v224, v225
    v_fma_f32 v186, v186, v224, v225
    v_fma_f32 v187, v187, v224, v225
    v_fma_f32 v188, v188, v224, v225
    v_fma_f32 v189, v189, v224, v225
    v_fma_f32 v190, v190, v224, v225
    v_fma_f32 v191, v191, v224, v225
    v_mul_f32 v16, v176, v176
    v_mul_f32 v17, v177, v177
    v_mul_f32 v18, v178, v178
    v_mul_f32 v19, v179, v179
    v_mul_f32 v20, v180, v180
    v_mul_f32 v21, v181, v181
    v_mul_f32 v22, v182, v182
    v_mul_f32 v23, v183, v183
    v_mul_f32 v24, v184, v184
    v_mul_f32 v25, v185, v185
    v_mul_f32 v26, v186, v186
    v_mul_f32 v27, v187, v187
    v_mul_f32 v28, v188, v188
    v_mul_f32 v29, v189, v189
    v_mul_f32 v30, v190, v190
    v_mul_f32 v31, v191, v191
    v_fma_f32 v16, v16, s60, v9
    v_fma_f32 v17, v17, s60, v9
    v_fma_f32 v18, v18, s60, v9
    v_fma_f32 v19, v19, s60, v9
    v_fma_f32 v20, v20, s60, v9
    v_fma_f32 v21, v21, s60, v9
    v_fma_f32 v22, v22, s60, v9
    v_fma_f32 v23, v23, s60, v9
    v_fma_f32 v24, v24, s60, v9
    v_fma_f32 v25, v25, s60, v9
    v_fma_f32 v26, v26, s60, v9
    v_fma_f32 v27, v27, s60, v9
    v_fma_f32 v28, v28, s60, v9
    v_fma_f32 v29, v29, s60, v9
    v_fma_f32 v30, v30, s60, v9
    v_fma_f32 v31, v31, s60, v9
    v_mul_f32 v16, v16, v176
    v_mul_f32 v17, v17, v177
    v_mul_f32 v18, v18, v178
    v_mul_f32 v19, v19, v179
    v_mul_f32 v20, v20, v180
    v_mul_f32 v21, v21, v181
    v_mul_f32 v22, v22, v182
    v_mul_f32 v23, v23, v183
    v_mul_f32 v24, v24, v184
    v_mul_f32 v25, v25, v185
    v_mul_f32 v26, v26, v186
    v_mul_f32 v27, v27, v187
    v_mul_f32 v28, v28, v188
    v_mul_f32 v29, v29, v189
    v_mul_f32 v30, v30, v190
    v_mul_f32 v31, v31, v191
    v_exp_f32 v16, v16
    v_exp_f32 v17, v17
    v_exp_f32 v18, v18
    v_exp_f32 v19, v19
    v_exp_f32 v20, v20
    v_exp_f32 v21, v21
    v_exp_f32 v22, v22
    v_exp_f32 v23, v23
    v_exp_f32 v24, v24
    v_exp_f32 v25, v25
    v_exp_f32 v26, v26
    v_exp_f32 v27, v27
    v_exp_f32 v28, v28
    v_exp_f32 v29, v29
    v_exp_f32 v30, v30
    v_exp_f32 v31, v31
    v_add_f32 v16, 1.0, v16
    v_add_f32 v17, 1.0, v17
    v_add_f32 v18, 1.0, v18
    v_add_f32 v19, 1.0, v19
    v_add_f32 v20, 1.0, v20
    v_add_f32 v21, 1.0, v21
    v_add_f32 v22, 1.0, v22
    v_add_f32 v23, 1.0, v23
    v_add_f32 v24, 1.0, v24
    v_add_f32 v25, 1.0, v25
    v_add_f32 v26, 1.0, v26
    v_add_f32 v27, 1.0, v27
    v_add_f32 v28, 1.0, v28
    v_add_f32 v29, 1.0, v29
    v_add_f32 v30, 1.0, v30
    v_add_f32 v31, 1.0, v31
    v_rcp_f32 v16, v16
    v_rcp_f32 v17, v17
    v_rcp_f32 v18, v18
    v_rcp_f32 v19, v19
    v_rcp_f32 v20, v20
    v_rcp_f32 v21, v21
    v_rcp_f32 v22, v22
    v_rcp_f32 v23, v23
    v_rcp_f32 v24, v24
    v_rcp_f32 v25, v25
    v_rcp_f32 v26, v26
    v_rcp_f32 v27, v27
    v_rcp_f32 v28, v28
    v_rcp_f32 v29, v29
    v_rcp_f32 v30, v30
    v_rcp_f32 v31, v31
    v_mul_f32 v176, v176, v16
    v_mul_f32 v177, v177, v17
    v_mul_f32 v178, v178, v18
    v_mul_f32 v179, v179, v19
    v_mul_f32 v180, v180, v20
    v_mul_f32 v181, v181, v21
    v_mul_f32 v182, v182, v22
    v_mul_f32 v183, v183, v23
    v_mul_f32 v184, v184, v24
    v_mul_f32 v185, v185, v25
    v_mul_f32 v186, v186, v26
    v_mul_f32 v187, v187, v27
    v_mul_f32 v188, v188, v28
    v_mul_f32 v189, v189, v29
    v_mul_f32 v190, v190, v30
    v_mul_f32 v191, v191, v31
    s_add_u32 s45, s44, 98304
    v_cvt_pk_bf16_f32 v32, v176, v177
    s_nop 1
    v_mov_b32_dpp v33, v32 quad_perm:[1,0,3,2] row_mask:0xf bank_mask:0xf
    v_perm_b32 v32, v33, v32, v7
    v_add_u32 v2, 96, v4
    v_cmp_gt_u32 vcc, s46, v2
    s_and_saveexec_b64 s[56:57], vcc
    buffer_store_dword v32, v8, s[64:67], s45 offen offset:0
    s_mov_b64 exec, s[56:57]
    v_cvt_pk_bf16_f32 v34, v178, v179
    s_nop 1
    v_mov_b32_dpp v35, v34 quad_perm:[1,0,3,2] row_mask:0xf bank_mask:0xf
    v_perm_b32 v34, v35, v34, v7
    v_add_u32 v2, 98, v4
    v_cmp_gt_u32 vcc, s46, v2
    s_and_saveexec_b64 s[56:57], vcc
    buffer_store_dword v34, v8, s[64:67], s45 offen offset:2048
    s_mov_b64 exec, s[56:57]
    s_add_u32 s45, s44, 106496
    v_cvt_pk_bf16_f32 v36, v180, v181
    s_nop 1
    v_mov_b32_dpp v37, v36 quad_perm:[1,0,3,2] row_mask:0xf bank_mask:0xf
    v_perm_b32 v36, v37, v36, v7
    v_add_u32 v2, 104, v4
    v_cmp_gt_u32 vcc, s46, v2
    s_and_saveexec_b64 s[56:57], vcc
    buffer_store_dword v36, v8, s[64:67], s45 offen offset:0
    s_mov_b64 exec, s[56:57]
    v_cvt_pk_bf16_f32 v38, v182, v183
    s_nop 1
    v_mov_b32_dpp v39, v38 quad_perm:[1,0,3,2] row_mask:0xf bank_mask:0xf
    v_perm_b32 v38, v39, v38, v7
    v_add_u32 v2, 106, v4
    v_cmp_gt_u32 vcc, s46, v2
    s_and_saveexec_b64 s[56:57], vcc
    buffer_store_dword v38, v8, s[64:67], s45 offen offset:2048
    s_mov_b64 exec, s[56:57]
    s_add_u32 s45, s44, 114688
    v_cvt_pk_bf16_f32 v40, v184, v185
    s_nop 1
    v_mov_b32_dpp v41, v40 quad_perm:[1,0,3,2] row_mask:0xf bank_mask:0xf
    v_perm_b32 v40, v41, v40, v7
    v_add_u32 v2, 112, v4
    v_cmp_gt_u32 vcc, s46, v2
    s_and_saveexec_b64 s[56:57], vcc
    buffer_store_dword v40, v8, s[64:67], s45 offen offset:0
    s_mov_b64 exec, s[56:57]
    v_cvt_pk_bf16_f32 v42, v186, v187
    s_nop 1
    v_mov_b32_dpp v43, v42 quad_perm:[1,0,3,2] row_mask:0xf bank_mask:0xf
    v_perm_b32 v42, v43, v42, v7
    v_add_u32 v2, 114, v4
    v_cmp_gt_u32 vcc, s46, v2
    s_and_saveexec_b64 s[56:57], vcc
    buffer_store_dword v42, v8, s[64:67], s45 offen offset:2048
    s_mov_b64 exec, s[56:57]
    s_add_u32 s45, s44, 122880
    v_cvt_pk_bf16_f32 v44, v188, v189
    s_nop 1
    v_mov_b32_dpp v45, v44 quad_perm:[1,0,3,2] row_mask:0xf bank_mask:0xf
    v_perm_b32 v44, v45, v44, v7
    v_add_u32 v2, 120, v4
    v_cmp_gt_u32 vcc, s46, v2
    s_and_saveexec_b64 s[56:57], vcc
    buffer_store_dword v44, v8, s[64:67], s45 offen offset:0
    s_mov_b64 exec, s[56:57]
    v_cvt_pk_bf16_f32 v46, v190, v191
    s_nop 1
    v_mov_b32_dpp v47, v46 quad_perm:[1,0,3,2] row_mask:0xf bank_mask:0xf
    v_perm_b32 v46, v47, v46, v7
    v_add_u32 v2, 122, v4
    v_cmp_gt_u32 vcc, s46, v2
    s_and_saveexec_b64 s[56:57], vcc
    buffer_store_dword v46, v8, s[64:67], s45 offen offset:2048
    s_mov_b64 exec, s[56:57]
    v_fma_f32 v192, v192, v226, v227
    v_fma_f32 v193, v193, v226, v227
    v_fma_f32 v194, v194, v226, v227
    v_fma_f32 v195, v195, v226, v227
    v_fma_f32 v196, v196, v226, v227
    v_fma_f32 v197, v197, v226, v227
    v_fma_f32 v198, v198, v226, v227
    v_fma_f32 v199, v199, v226, v227
    v_fma_f32 v200, v200, v226, v227
    v_fma_f32 v201, v201, v226, v227
    v_fma_f32 v202, v202, v226, v227
    v_fma_f32 v203, v203, v226, v227
    v_fma_f32 v204, v204, v226, v227
    v_fma_f32 v205, v205, v226, v227
    v_fma_f32 v206, v206, v226, v227
    v_fma_f32 v207, v207, v226, v227
    v_mul_f32 v16, v192, v192
    v_mul_f32 v17, v193, v193
    v_mul_f32 v18, v194, v194
    v_mul_f32 v19, v195, v195
    v_mul_f32 v20, v196, v196
    v_mul_f32 v21, v197, v197
    v_mul_f32 v22, v198, v198
    v_mul_f32 v23, v199, v199
    v_mul_f32 v24, v200, v200
    v_mul_f32 v25, v201, v201
    v_mul_f32 v26, v202, v202
    v_mul_f32 v27, v203, v203
    v_mul_f32 v28, v204, v204
    v_mul_f32 v29, v205, v205
    v_mul_f32 v30, v206, v206
    v_mul_f32 v31, v207, v207
    v_fma_f32 v16, v16, s60, v9
    v_fma_f32 v17, v17, s60, v9
    v_fma_f32 v18, v18, s60, v9
    v_fma_f32 v19, v19, s60, v9
    v_fma_f32 v20, v20, s60, v9
    v_fma_f32 v21, v21, s60, v9
    v_fma_f32 v22, v22, s60, v9
    v_fma_f32 v23, v23, s60, v9
    v_fma_f32 v24, v24, s60, v9
    v_fma_f32 v25, v25, s60, v9
    v_fma_f32 v26, v26, s60, v9
    v_fma_f32 v27, v27, s60, v9
    v_fma_f32 v28, v28, s60, v9
    v_fma_f32 v29, v29, s60, v9
    v_fma_f32 v30, v30, s60, v9
    v_fma_f32 v31, v31, s60, v9
    v_mul_f32 v16, v16, v192
    v_mul_f32 v17, v17, v193
    v_mul_f32 v18, v18, v194
    v_mul_f32 v19, v19, v195
    v_mul_f32 v20, v20, v196
    v_mul_f32 v21, v21, v197
    v_mul_f32 v22, v22, v198
    v_mul_f32 v23, v23, v199
    v_mul_f32 v24, v24, v200
    v_mul_f32 v25, v25, v201
    v_mul_f32 v26, v26, v202
    v_mul_f32 v27, v27, v203
    v_mul_f32 v28, v28, v204
    v_mul_f32 v29, v29, v205
    v_mul_f32 v30, v30, v206
    v_mul_f32 v31, v31, v207
    v_exp_f32 v16, v16
    v_exp_f32 v17, v17
    v_exp_f32 v18, v18
    v_exp_f32 v19, v19
    v_exp_f32 v20, v20
    v_exp_f32 v21, v21
    v_exp_f32 v22, v22
    v_exp_f32 v23, v23
    v_exp_f32 v24, v24
    v_exp_f32 v25, v25
    v_exp_f32 v26, v26
    v_exp_f32 v27, v27
    v_exp_f32 v28, v28
    v_exp_f32 v29, v29
    v_exp_f32 v30, v30
    v_exp_f32 v31, v31
    v_add_f32 v16, 1.0, v16
    v_add_f32 v17, 1.0, v17
    v_add_f32 v18, 1.0, v18
    v_add_f32 v19, 1.0, v19
    v_add_f32 v20, 1.0, v20
    v_add_f32 v21, 1.0, v21
    v_add_f32 v22, 1.0, v22
    v_add_f32 v23, 1.0, v23
    v_add_f32 v24, 1.0, v24
    v_add_f32 v25, 1.0, v25
    v_add_f32 v26, 1.0, v26
    v_add_f32 v27, 1.0, v27
    v_add_f32 v28, 1.0, v28
    v_add_f32 v29, 1.0, v29
    v_add_f32 v30, 1.0, v30
    v_add_f32 v31, 1.0, v31
    v_rcp_f32 v16, v16
    v_rcp_f32 v17, v17
    v_rcp_f32 v18, v18
    v_rcp_f32 v19, v19
    v_rcp_f32 v20, v20
    v_rcp_f32 v21, v21
    v_rcp_f32 v22, v22
    v_rcp_f32 v23, v23
    v_rcp_f32 v24, v24
    v_rcp_f32 v25, v25
    v_rcp_f32 v26, v26
    v_rcp_f32 v27, v27
    v_rcp_f32 v28, v28
    v_rcp_f32 v29, v29
    v_rcp_f32 v30, v30
    v_rcp_f32 v31, v31
    v_mul_f32 v192, v192, v16
    v_mul_f32 v193, v193, v17
    v_mul_f32 v194, v194, v18
    v_mul_f32 v195, v195, v19
    v_mul_f32 v196, v196, v20
    v_mul_f32 v197, v197, v21
    v_mul_f32 v198, v198, v22
    v_mul_f32 v199, v199, v23
    v_mul_f32 v200, v200, v24
    v_mul_f32 v201, v201, v25
    v_mul_f32 v202, v202, v26
    v_mul_f32 v203, v203, v27
    v_mul_f32 v204, v204, v28
    v_mul_f32 v205, v205, v29
    v_mul_f32 v206, v206, v30
    v_mul_f32 v207, v207, v31
    s_add_u32 s45, s44, 98304
    v_cvt_pk_bf16_f32 v32, v192, v193
    s_nop 1
    v_mov_b32_dpp v33, v32 quad_perm:[1,0,3,2] row_mask:0xf bank_mask:0xf
    v_perm_b32 v32, v33, v32, v7
    v_add_u32 v2, 96, v4
    v_cmp_gt_u32 vcc, s46, v2
    s_and_saveexec_b64 s[56:57], vcc
    buffer_store_dword v32, v8, s[64:67], s45 offen offset:64
    s_mov_b64 exec, s[56:57]
    v_cvt_pk_bf16_f32 v34, v194, v195
    s_nop 1
    v_mov_b32_dpp v35, v34 quad_perm:[1,0,3,2] row_mask:0xf bank_mask:0xf
    v_perm_b32 v34, v35, v34, v7
    v_add_u32 v2, 98, v4
    v_cmp_gt_u32 vcc, s46, v2
    s_and_saveexec_b64 s[56:57], vcc
    buffer_store_dword v34, v8, s[64:67], s45 offen offset:2112
    s_mov_b64 exec, s[56:57]
    s_add_u32 s45, s44, 106496
    v_cvt_pk_bf16_f32 v36, v196, v197
    s_nop 1
    v_mov_b32_dpp v37, v36 quad_perm:[1,0,3,2] row_mask:0xf bank_mask:0xf
    v_perm_b32 v36, v37, v36, v7
    v_add_u32 v2, 104, v4
    v_cmp_gt_u32 vcc, s46, v2
    s_and_saveexec_b64 s[56:57], vcc
    buffer_store_dword v36, v8, s[64:67], s45 offen offset:64
    s_mov_b64 exec, s[56:57]
    v_cvt_pk_bf16_f32 v38, v198, v199
    s_nop 1
    v_mov_b32_dpp v39, v38 quad_perm:[1,0,3,2] row_mask:0xf bank_mask:0xf
    v_perm_b32 v38, v39, v38, v7
    v_add_u32 v2, 106, v4
    v_cmp_gt_u32 vcc, s46, v2
    s_and_saveexec_b64 s[56:57], vcc
    buffer_store_dword v38, v8, s[64:67], s45 offen offset:2112
    s_mov_b64 exec, s[56:57]
    s_add_u32 s45, s44, 114688
    v_cvt_pk_bf16_f32 v40, v200, v201
    s_nop 1
    v_mov_b32_dpp v41, v40 quad_perm:[1,0,3,2] row_mask:0xf bank_mask:0xf
    v_perm_b32 v40, v41, v40, v7
    v_add_u32 v2, 112, v4
    v_cmp_gt_u32 vcc, s46, v2
    s_and_saveexec_b64 s[56:57], vcc
    buffer_store_dword v40, v8, s[64:67], s45 offen offset:64
    s_mov_b64 exec, s[56:57]
    v_cvt_pk_bf16_f32 v42, v202, v203
    s_nop 1
    v_mov_b32_dpp v43, v42 quad_perm:[1,0,3,2] row_mask:0xf bank_mask:0xf
    v_perm_b32 v42, v43, v42, v7
    v_add_u32 v2, 114, v4
    v_cmp_gt_u32 vcc, s46, v2
    s_and_saveexec_b64 s[56:57], vcc
    buffer_store_dword v42, v8, s[64:67], s45 offen offset:2112
    s_mov_b64 exec, s[56:57]
    s_add_u32 s45, s44, 122880
    v_cvt_pk_bf16_f32 v44, v204, v205
    s_nop 1
    v_mov_b32_dpp v45, v44 quad_perm:[1,0,3,2] row_mask:0xf bank_mask:0xf
    v_perm_b32 v44, v45, v44, v7
    v_add_u32 v2, 120, v4
    v_cmp_gt_u32 vcc, s46, v2
    s_and_saveexec_b64 s[56:57], vcc
    buffer_store_dword v44, v8, s[64:67], s45 offen offset:64
    s_mov_b64 exec, s[56:57]
    v_cvt_pk_bf16_f32 v46, v206, v207
    s_nop 1
    v_mov_b32_dpp v47, v46 quad_perm:[1,0,3,2] row_mask:0xf bank_mask:0xf
    v_perm_b32 v46, v47, v46, v7
    v_add_u32 v2, 122, v4
    v_cmp_gt_u32 vcc, s46, v2
    s_and_saveexec_b64 s[56:57], vcc
    buffer_store_dword v46, v8, s[64:67], s45 offen offset:2112
    s_mov_b64 exec, s[56:57]
L_k1_end:
    s_endpgm
.section .rodata,"a"
.p2align 6
.amdhsa_kernel standalone__self_sup_conv_stem_hubert__speech_kernel
  .amdhsa_next_free_vgpr 256
  .amdhsa_next_free_sgpr 100
  .amdhsa_accum_offset 256
  .amdhsa_group_segment_fixed_size 0
  .amdhsa_kernarg_size 64
  .amdhsa_user_sgpr_count 2
  .amdhsa_user_sgpr_kernarg_segment_ptr 1
  .amdhsa_system_sgpr_workgroup_id_x 1
.end_amdhsa_kernel
```
